```python
import torch

def _softmax(x, axis=-1):
    return torch.softmax(x, dim=axis)
def _gelu(x):
    return torch.nn.functional.gelu(x, approximate="tanh")
def _silu(x):
    return torch.nn.functional.silu(x)
def _sigmoid(x):
    return torch.sigmoid(x)
def _layernorm(x, axis=-1, eps=1e-5):
    m = x.mean(dim=axis, keepdim=True)
    v = x.var(dim=axis, keepdim=True, unbiased=False)
    return (x - m) / torch.sqrt(v + eps)
def _scatter_add(tgt, idx, src, axis=0):
    return tgt.clone().index_add_(axis, idx, src)
def _segment_sum(src, seg, n):
    out = torch.zeros((n,) + src.shape[1:], dtype=src.dtype)
    return out.index_add_(0, seg, src)
def _pad(x, pw):
    flat = tuple(v for pair in reversed(pw) for v in pair)
    return torch.nn.functional.pad(x, flat)

kernel_name = 'parallel_sum__ssm_conv_h3__glu_gated_bilinear__prompt'

def setup_inputs():

    _w = (lambda a: (lambda t: t.to(torch.bfloat16) if t.is_floating_point() else t)(torch.as_tensor(a)))
    def _A_setup():
        B, S, D = 1, 2048, 512
        ks = 4
        return {
            "q": _w((lambda *s: torch.randn(*s, dtype=torch.bfloat16) * 0.05)(B, S, D)),
            "k": _w((lambda *s: torch.randn(*s, dtype=torch.bfloat16) * 0.2)(B, S, D)),
            "v": _w((lambda *s: torch.randn(*s, dtype=torch.bfloat16) * 0.2)(B, S, D)),
            "shift_k": _w((lambda *s: torch.randn(*s, dtype=torch.bfloat16) * 0.2)(D, ks) * 0.5),
            "ssm_k": _w((lambda *s: torch.randn(*s, dtype=torch.bfloat16) * 0.4)(D, S) * (1.0 / S ** 0.5)),
            "ssm_D": _w((lambda *s: torch.randn(*s, dtype=torch.bfloat16) * 0.2)(D)),
        }
    _A_in = _A_setup()

    def _B_setup():
        B, S, D, F = 1, 2048, 512, 1376
        return {
            "x": _w((lambda *s: torch.randn(*s, dtype=torch.bfloat16) * 0.05)(B, S, D)),
            "w_gate": _w((lambda *s: torch.randn(*s, dtype=torch.bfloat16) * 0.2)(D, F) * (D ** -0.5)),
            "w_up": _w((lambda *s: torch.randn(*s, dtype=torch.bfloat16) * 0.2)(D, F) * (D ** -0.5)),
            "w_down": _w((lambda *s: torch.randn(*s, dtype=torch.bfloat16) * 0.2)(F, D) * (F ** -0.5)),
        }
    _B_in = _B_setup()

    return {
        "A_q": _A_in["q"],
        "A_k": _A_in["k"],
        "A_v": _A_in["v"],
        "A_shift_k": _A_in["shift_k"],
        "A_ssm_k": _A_in["ssm_k"],
        "A_ssm_D": _A_in["ssm_D"],
        "B_x": _B_in["x"],
        "B_w_gate": _B_in["w_gate"],
        "B_w_up": _B_in["w_up"],
        "B_w_down": _B_in["w_down"],
    }

def reference(A_q, A_k, A_v, A_shift_k, A_ssm_k, A_ssm_D, B_x, B_w_gate, B_w_up, B_w_down):
    def _A_ref(q, k, v, shift_k, ssm_k, ssm_D):
        B, S, D = q.shape
        ks = shift_k.shape[-1]
        k_pad = _pad(k, ((0, 0), (ks - 1, 0), (0, 0)))
        k_shift = torch.zeros_like(k)
        for t in range(ks):
            k_shift = k_shift + k_pad[:, t:t + S, :] * shift_k[:, ks - 1 - t][None, None, :]
        kv = k_shift * v
        L = 2 * S
        kv_pad = _pad(kv, ((0, 0), (0, S), (0, 0)))
        kf_pad = _pad(ssm_k, ((0, 0), (0, S)))
        kv_f = (lambda x, axes=(-2,-1): torch.fft.rfft2(x.float(), dim=axes))(kv_pad[:, None, :, :], axes=(1, 2))
        kf_f = (lambda x, axes=(-2,-1): torch.fft.rfft2(x.float(), dim=axes))(kf_pad[:, None, :], axes=(1, 2))
        kf_f = (lambda x, *d: x.permute(*d))(kf_f, 1, 2, 0)
        y_f = kv_f * kf_f[None, :, :, :]
        y = (lambda x, s, axes=(-2,-1): torch.fft.irfft2(x, s=s, dim=axes).to(torch.bfloat16))(y_f, (1, L), axes=(1, 2))[:, 0, :S, :]
        y = y + kv * ssm_D[None, None, :]
        return q * y

    def _B_ref(x, w_gate, w_up, w_down):
        g = torch.einsum("bsd,df->bsf", x, w_gate)
        u = torch.einsum("bsd,df->bsf", x, w_up)
        h = g * u
        return torch.einsum("bsf,fd->bsd", h, w_down)

    x = A_q
    xn = _layernorm(x, axis=-1)
    return x + _A_ref(xn, A_k, A_v, A_shift_k, A_ssm_k, A_ssm_D) + _B_ref(xn, B_w_gate, B_w_up, B_w_down)
```

```asm
; @launch grid=(512,1,1) block=(256,1,1) lds=81920
.amdgcn_target "amdgcn-amd-amdhsa--gfx950"
.text
.globl parallel_sum__ssm_conv_h3__glu_gated_bilinear__prompt_kernel
.p2align 8
.type parallel_sum__ssm_conv_h3__glu_gated_bilinear__prompt_kernel,@function
parallel_sum__ssm_conv_h3__glu_gated_bilinear__prompt_kernel:
    s_cmp_ge_u32 s2, 512
    s_cbranch_scc1 k_done
    s_load_dwordx16 s[64:79], s[0:1], 0
    s_load_dwordx8 s[80:87], s[0:1], 64
    s_load_dwordx2 s[88:89], s[0:1], 96
    s_memrealtime s[90:91]
    s_mov_b32 s40, 0xffff0000
    v_and_b32 v1, 63, v0
    v_lshrrev_b32 v2, 6, v0
    v_lshlrev_b32 v247, 7, v1
    v_readfirstlane_b32 s3, v2
    s_waitcnt lgkmcnt(0)
    s_add_u32 s56, s88, 12582912
    s_addc_u32 s57, s89, 0
    s_and_b32 s57, s57, 0xffff
    s_mov_b32 s58, 720896
    s_mov_b32 s59, 0x00020000
    s_mov_b32 s60, s86
    s_and_b32 s61, s87, 0xffff
    s_mov_b32 s62, 256
    s_mov_b32 s63, 0x00020000
    s_cmp_ge_u32 s2, 256
    s_cbranch_scc1 c_type
    s_setprio 3
    s_or_b32 s34, s2, s3
    s_cmp_eq_u32 s34, 0
    s_cbranch_scc0 g_notok
    s_or_b32 s90, s90, 1
    v_mov_b32 v252, s90
    v_mov_b32 v253, s91
    s_mov_b64 exec, 1
    buffer_store_dwordx2 v[252:253], off, s[60:63], 0 sc0 sc1
    s_mov_b64 exec, -1
g_notok:
    s_lshr_b32 s33, s2, 3
    s_and_b32 s30, s2, 4
    s_lshl_b32 s30, s30, 1
    s_lshr_b32 s31, s33, 2
    s_add_u32 s30, s30, s31
    s_and_b32 s31, s2, 3
    s_lshl_b32 s31, s31, 2
    s_and_b32 s34, s33, 3
    s_add_u32 s31, s31, s34
    s_and_b32 s4, s2, 7
    s_lshl_b32 s4, s4, 2
    s_lshr_b32 s34, s33, 3
    s_add_u32 s4, s4, s34
    s_mov_b32 s16, s64
    s_and_b32 s17, s65, 0xffff
    s_mov_b32 s18, 2097152
    s_mov_b32 s19, 0x00020000
    s_lshl_b32 s35, s30, 7
    s_lshl_b32 s34, s31, 3
    s_add_u32 s35, s35, s34
    s_lshl_b32 s34, s3, 1
    s_add_u32 s35, s35, s34
    s_lshl_b32 s34, s35, 10
    v_lshrrev_b32 v12, 5, v1
    v_and_b32 v13, 31, v1
    v_lshlrev_b32 v13, 4, v13
    v_lshl_add_u32 v12, v12, 10, v13
    buffer_load_dwordx4 v[120:123], v12, s[16:19], s34 offen
    buffer_load_dwordx4 v[124:127], v12, s[16:19], s34 offen offset:512
    s_lshl_b32 s35, s35, 4
    s_lshl_b32 s32, s30, 17
    s_lshl_b32 s34, s3, 15
    s_add_u32 s32, s32, s34
    s_lshr_b32 s46, s32, 6
    s_bitset0_b32 s46, 9
    v_lshrrev_b32 v12, 3, v1
    v_lshrrev_b32 v13, 4, v1
    v_xor_b32 v13, v13, v1
    v_and_b32 v13, 7, v13
    v_lshlrev_b32 v13, 4, v13
    v_lshl_add_u32 v20, v12, 10, v13
    v_xor_b32 v21, 64, v20
    s_lshl_b32 s7, s3, 12
    s_lshr_b32 s29, s33, 2
    s_and_b32 s34, s33, 3
    s_lshl_b32 s34, s34, 1
    s_lshl_b32 s29, s29, 1
    s_lshl_b32 s29, s29, 1
    s_and_b32 s29, s29, 15
    s_lshl_b32 s34, s29, 6
    s_add_u32 s32, s32, s34
    s_add_u32 s24, s88, 4194304
    s_addc_u32 s25, s89, 0
    s_and_b32 s25, s25, 0xffff
    s_mov_b32 s26, 5636096
    s_mov_b32 s27, 0x00020000
    s_add_u32 s12, s88, 0
    s_addc_u32 s13, s89, 0
    s_and_b32 s13, s13, 0xffff
    s_mov_b32 s14, 32768
    s_mov_b32 s15, 0x00020000
    s_mov_b32 s6, 0x3f803f80
    v_lshlrev_b32 v8, 4, v1
    s_lshl_b32 s47, s4, 10
    s_and_b32 s34, s3, 1
    s_lshl_b32 s34, s34, 9
    s_add_u32 s47, s47, s34
    s_mov_b32 s8, s82
    s_and_b32 s9, s83, 0xffff
    s_mov_b32 s10, 1409024
    s_mov_b32 s11, 0x00020000
    s_mul_i32 s51, s3, 22
    s_cmp_eq_u32 s3, 3
    s_cselect_b32 s51, 65, s51
    s_lshl_b32 s41, s51, 14
    s_lshr_b32 s34, s3, 1
    s_lshl_b32 s34, s34, 14
    s_sub_u32 s41, s41, s34
    s_lshl_b32 s37, s3, 11
    v_lshrrev_b32 v14, 3, v1
    v_lshlrev_b32 v22, 10, v14
    v_and_b32 v14, 7, v1
    v_bfe_u32 v15, v1, 4, 1
    v_lshlrev_b32 v15, 2, v15
    v_xor_b32 v14, v14, v15
    v_lshl_add_u32 v22, v14, 4, v22
    s_and_b32 s34, s33, 7
    s_lshl_b32 s34, s34, 7
    v_add_u32 v22, s34, v22
    s_lshl_b32 s36, s30, 2
    s_add_u32 s36, s36, s3
    s_lshl_b32 s39, s36, 7
    s_lshl_b32 s38, s31, 3
    s_add_u32 s39, s39, s38
    s_add_u32 s39, s39, 16384
    s_bitset0_b32 s36, 0
    s_mul_i32 s42, s36, 88064
    s_mul_i32 s36, s31, 3
    s_add_u32 s38, s31, 1
    s_lshr_b32 s38, s38, 4
    s_sub_u32 s36, s36, s38
    s_lshr_b32 s38, s31, 2
    s_sub_u32 s36, s36, s38
    s_lshl_b32 s36, s36, 6
    s_lshl_b32 s38, s36, 5
    s_add_u32 s42, s42, s38
    s_bitcmp1_b32 0xc888, s31
    s_cbranch_scc1 g_path2
    s_add_u32 m0, s7, 0
    s_nop 0
    buffer_load_dwordx4 v20, s[16:19], s32 offen offset:0 lds
    s_add_u32 s38, s32, 7168
    buffer_load_dwordx4 v21, s[16:19], s38 offen offset:1024 lds
    s_add_u32 s38, s32, 14336
    buffer_load_dwordx4 v20, s[16:19], s38 offen offset:2048 lds
    s_add_u32 s38, s32, 21504
    buffer_load_dwordx4 v21, s[16:19], s38 offen offset:3072 lds
    s_mul_i32 s43, s3, 3072
    s_lshr_b32 s5, s3, 1
    s_cmp_eq_u32 s5, 1
    s_cselect_b32 s52, s80, s78
    s_cselect_b32 s53, s81, s79
    s_and_b32 s53, s53, 0xffff
    s_mov_b32 s54, 1409024
    s_mov_b32 s55, 0x00020000
    s_and_b32 s49, s3, 1
    s_mul_i32 s38, s49, 3072
    s_add_u32 s42, s42, s38
    s_mul_i32 s48, s49, 16*2752
    s_add_u32 s48, s48, s36
    s_movk_i32 s49, 2752
    s_lshl_b32 s34, s5, 1
    v_add_u32 v14, 0, v1
    v_mul_u32_u24 v15, 0x5556, v14
    v_lshrrev_b32 v15, 18, v15
    v_mul_u32_u24 v13, 12, v15
    v_sub_u32 v14, v14, v13
    v_xor_b32 v14, s34, v14
    v_mul_lo_u32 v15, v15, s49
    v_lshl_add_u32 v17, v14, 4, v15
    v_add_u32 v14, 64, v1
    v_mul_u32_u24 v15, 0x5556, v14
    v_lshrrev_b32 v15, 18, v15
    v_mul_u32_u24 v13, 12, v15
    v_sub_u32 v14, v14, v13
    v_xor_b32 v14, s34, v14
    v_mul_lo_u32 v15, v15, s49
    v_lshl_add_u32 v18, v14, 4, v15
    v_subrev_u32 v18, 1024, v18
    v_add_u32 v14, 128, v1
    v_mul_u32_u24 v15, 0x5556, v14
    v_lshrrev_b32 v15, 18, v15
    v_mul_u32_u24 v13, 12, v15
    v_sub_u32 v14, v14, v13
    v_xor_b32 v14, s34, v14
    v_mul_lo_u32 v15, v15, s49
    v_lshl_add_u32 v19, v14, 4, v15
    v_subrev_u32 v19, 2048, v19
    s_add_u32 s49, s48, 1409024
    s_mul_i32 s38, s29, 88064
    s_add_u32 s48, s48, s38
    s_add_u32 m0, s43, 32768
    s_nop 0
    buffer_load_dwordx4 v17, s[52:55], s48 offen offset:0 lds
    buffer_load_dwordx4 v18, s[52:55], s48 offen offset:1024 lds
    buffer_load_dwordx4 v19, s[52:55], s48 offen offset:2048 lds
    s_add_u32 s48, s48, 88064
    s_cmp_ge_u32 s48, s49
    s_cselect_b32 s38, 1409024, 0
    s_sub_u32 s48, s48, s38
    s_add_u32 m0, s43, 45056
    s_nop 0
    buffer_load_dwordx4 v17, s[52:55], s48 offen offset:0 lds
    buffer_load_dwordx4 v18, s[52:55], s48 offen offset:1024 lds
    buffer_load_dwordx4 v19, s[52:55], s48 offen offset:2048 lds
    s_add_u32 s32, s32, 128
    s_bitset0_b32 s32, 10
    s_add_u32 m0, s7, 16384
    s_nop 0
    buffer_load_dwordx4 v20, s[16:19], s32 offen offset:0 lds
    s_add_u32 s38, s32, 7168
    buffer_load_dwordx4 v21, s[16:19], s38 offen offset:1024 lds
    s_add_u32 s38, s32, 14336
    buffer_load_dwordx4 v20, s[16:19], s38 offen offset:2048 lds
    s_add_u32 s38, s32, 21504
    buffer_load_dwordx4 v21, s[16:19], s38 offen offset:3072 lds
    s_add_u32 s48, s48, 88064
    s_cmp_ge_u32 s48, s49
    s_cselect_b32 s38, 1409024, 0
    s_sub_u32 s48, s48, s38
    s_add_u32 m0, s43, 57344
    s_nop 0
    buffer_load_dwordx4 v17, s[52:55], s48 offen offset:0 lds
    buffer_load_dwordx4 v18, s[52:55], s48 offen offset:1024 lds
    buffer_load_dwordx4 v19, s[52:55], s48 offen offset:2048 lds
    s_add_u32 s48, s48, 88064
    s_cmp_ge_u32 s48, s49
    s_cselect_b32 s38, 1409024, 0
    s_sub_u32 s48, s48, s38
    s_add_u32 m0, s43, 69632
    s_nop 0
    buffer_load_dwordx4 v17, s[52:55], s48 offen offset:0 lds
    buffer_load_dwordx4 v18, s[52:55], s48 offen offset:1024 lds
    buffer_load_dwordx4 v19, s[52:55], s48 offen offset:2048 lds
    v_lshrrev_b32 v3, 5, v1
    v_and_b32 v2, 15, v1
    v_lshrrev_b32 v4, 2, v2
    v_lshl_add_u32 v4, v3, 3, v4
    v_mul_u32_u24 v4, 192, v4
    v_bfe_u32 v5, v1, 4, 1
    v_mul_u32_u24 v6, 6144, v5
    v_add_u32 v4, v4, v6
    v_and_b32 v2, 3, v2
    v_lshl_add_u32 v4, v2, 3, v4
    v_lshlrev_b32 v5, 5, v5
    s_and_b32 s34, s3, 1
    s_mul_i32 s34, s34, 96
    s_mul_i32 s38, s5, 3072
    s_add_u32 s38, s38, 32768
    v_add_u32 v4, s38, v4
    s_add_u32 s38, s34, 0
    v_xor_b32 v6, s38, v5
    v_add_u32 v13, v4, v6
    s_add_u32 s38, s34, 32
    v_xor_b32 v6, s38, v5
    v_add_u32 v14, v4, v6
    s_mul_i32 s38, s5, 6144
    s_sub_u32 s38, 3072, s38
    v_add_u32 v15, s38, v13
    v_add_u32 v16, s38, v14
    v_and_b32 v4, 31, v1
    v_bfe_u32 v5, v1, 1, 3
    v_xor_b32 v5, v5, v3
    v_lshlrev_b32 v5, 4, v5
    v_lshl_add_u32 v5, v4, 7, v5
    s_lshl_b32 s38, s5, 5
    v_xor_b32 v5, s38, v5
    s_lshl_b32 s38, s5, 13
    v_add_u32 v9, s38, v5
    v_xor_b32 v10, 32, v9
    v_xor_b32 v11, 64, v9
    v_xor_b32 v12, 96, v9
    v_lshrrev_b32 v2, 2, v1
    v_lshrrev_b32 v3, 4, v1
    v_xor_b32 v2, v2, v3
    v_and_b32 v2, 1, v2
    v_cmp_eq_u32 vcc, 0, v2
    v_mov_b32 v3, s6
    s_nop 0
    v_cndmask_b32 v24, 0, v3, vcc
    v_cndmask_b32 v25, 0, v3, vcc
    v_cndmask_b32 v26, 0, v3, vcc
    v_cndmask_b32 v27, 0, v3, vcc
    v_and_b32 v2, 31, v1
    v_lshrrev_b32 v3, 5, v1
    v_lshlrev_b32 v23, 10, v2
    v_lshl_add_u32 v23, v3, 3, v23
    s_lshl_b32 s38, s4, 1
    s_and_b32 s34, s3, 1
    s_add_u32 s38, s38, s34
    s_lshl_b32 s38, s38, 15
    s_and_b32 s34, s33, 7
    s_lshl_b32 s34, s34, 7
    s_add_u32 s38, s38, s34
    s_lshl_b32 s34, s5, 6
    s_add_u32 s38, s38, s34
    v_add_u32 v23, s38, v23
    v_mov_b32 v240, 0
    v_mov_b32 v241, 0
    v_mov_b32 v242, 0
    v_mov_b32 v243, 0
    s_waitcnt vmcnt(20)
    v_dot2c_f32_bf16 v240, s6, v120
    v_dot2c_f32_bf16 v242, v120, v120
    v_dot2c_f32_bf16 v241, s6, v121
    v_dot2c_f32_bf16 v243, v121, v121
    v_dot2c_f32_bf16 v240, s6, v122
    v_dot2c_f32_bf16 v242, v122, v122
    v_dot2c_f32_bf16 v241, s6, v123
    v_dot2c_f32_bf16 v243, v123, v123
    v_dot2c_f32_bf16 v240, s6, v124
    v_dot2c_f32_bf16 v242, v124, v124
    v_dot2c_f32_bf16 v241, s6, v125
    v_dot2c_f32_bf16 v243, v125, v125
    v_dot2c_f32_bf16 v240, s6, v126
    v_dot2c_f32_bf16 v242, v126, v126
    v_dot2c_f32_bf16 v241, s6, v127
    v_dot2c_f32_bf16 v243, v127, v127
    s_nop 3
    v_add_f32 v244, v240, v241
    v_add_f32 v245, v242, v243
    s_nop 1
    v_add_f32_dpp v246, v244, v244 quad_perm:[1,0,3,2] row_mask:0xf bank_mask:0xf
    v_add_f32_dpp v247, v245, v245 quad_perm:[1,0,3,2] row_mask:0xf bank_mask:0xf
    s_nop 1
    v_add_f32_dpp v244, v246, v246 quad_perm:[2,3,0,1] row_mask:0xf bank_mask:0xf
    v_add_f32_dpp v245, v247, v247 quad_perm:[2,3,0,1] row_mask:0xf bank_mask:0xf
    s_nop 1
    v_add_f32_dpp v246, v244, v244 row_half_mirror row_mask:0xf bank_mask:0xf
    v_add_f32_dpp v247, v245, v245 row_half_mirror row_mask:0xf bank_mask:0xf
    s_nop 1
    v_add_f32_dpp v244, v246, v246 row_mirror row_mask:0xf bank_mask:0xf
    v_add_f32_dpp v245, v247, v247 row_mirror row_mask:0xf bank_mask:0xf
    v_mov_b32 v246, v244
    v_mov_b32 v247, v245
    s_nop 1
    v_permlane16_swap_b32 v244, v246
    v_permlane16_swap_b32 v245, v247
    s_nop 1
    v_add_f32 v244, v244, v246
    v_add_f32 v245, v245, v247
    v_mul_f32 v244, 0x3b000000, v244
    v_mul_f32 v245, 0x3b000000, v245
    v_fma_f32 v245, -v244, v244, v245
    v_max_f32 v245, 0, v245
    v_cvt_pk_bf16_f32 v244, 0, v244
    v_cvt_pk_bf16_f32 v245, 0, v245
    v_add_f32 v245, 0x3727c5ac, v245
    v_cvt_pk_bf16_f32 v245, 0, v245
    v_sqrt_f32 v245, v245
    v_sub_f32 v228, 0, v244
    v_cvt_pk_bf16_f32 v245, 0, v245
    v_rcp_f32 v229, v245
    buffer_load_dwordx2 v[252:253], off, s[60:63], 0
    s_waitcnt vmcnt(14)
    s_barrier
    ds_read_b128 v[56:59], v9 offset:0
    ds_read_b128 v[60:63], v9 offset:4096
    ds_read_b64_tr_b16 v[32:33], v13 offset:0
    ds_read_b64_tr_b16 v[34:35], v13 offset:768
    ds_read_b64_tr_b16 v[36:37], v14 offset:0
    ds_read_b64_tr_b16 v[38:39], v14 offset:768
    ds_read_b64_tr_b16 v[40:41], v13 offset:64
    ds_read_b64_tr_b16 v[42:43], v13 offset:832
    ds_read_b128 v[64:67], v10 offset:0
    ds_read_b128 v[68:71], v10 offset:4096
    ds_read_b128 v[72:75], v11 offset:0
    ds_read_b128 v[76:79], v11 offset:4096
    ds_read_b128 v[80:83], v12 offset:0
    ds_read_b128 v[84:87], v12 offset:4096
    s_waitcnt lgkmcnt(10)
    v_mfma_f32_32x32x16_bf16 v[120:135], v[32:35], v[56:59], 0
    ds_read_b64_tr_b16 v[44:45], v15 offset:0
    ds_read_b64_tr_b16 v[46:47], v15 offset:768
    v_mfma_f32_32x32x16_bf16 v[136:151], v[32:35], v[60:63], 0
    ds_read_b64_tr_b16 v[48:49], v16 offset:0
    ds_read_b64_tr_b16 v[50:51], v16 offset:768
    v_mfma_f32_16x16x32_bf16 v[216:219], v[24:27], v[32:35], 0
    s_waitcnt lgkmcnt(12)
    v_mfma_f32_32x32x16_bf16 v[152:167], v[36:39], v[56:59], 0
    ds_read_b64_tr_b16 v[52:53], v15 offset:64
    ds_read_b64_tr_b16 v[54:55], v15 offset:832
    v_mfma_f32_32x32x16_bf16 v[168:183], v[36:39], v[60:63], 0
    v_mfma_f32_16x16x32_bf16 v[220:223], v[24:27], v[36:39], 0
    s_waitcnt lgkmcnt(12)
    v_mfma_f32_32x32x16_bf16 v[184:199], v[40:43], v[56:59], 0
    v_mfma_f32_32x32x16_bf16 v[200:215], v[40:43], v[60:63], 0
    v_mfma_f32_16x16x32_bf16 v[224:227], v[24:27], v[40:43], 0
    s_waitcnt vmcnt(11)
    s_waitcnt vmcnt(7)
    s_waitcnt lgkmcnt(0)
    s_barrier
    v_mfma_f32_32x32x16_bf16 v[120:135], v[44:47], v[64:67], v[120:135]
    ds_read_b64_tr_b16 v[32:33], v13 offset:12288
    ds_read_b64_tr_b16 v[34:35], v13 offset:13056
    v_mfma_f32_32x32x16_bf16 v[136:151], v[44:47], v[68:71], v[136:151]
    ds_read_b64_tr_b16 v[36:37], v14 offset:12288
    ds_read_b64_tr_b16 v[38:39], v14 offset:13056
    s_add_u32 s32, s32, 128
    s_bitset0_b32 s32, 10
    s_add_u32 m0, s7, 0
    s_nop 0
    buffer_load_dwordx4 v20, s[16:19], s32 offen offset:0 lds
    v_mfma_f32_32x32x16_bf16 v[152:167], v[48:51], v[64:67], v[152:167]
    ds_read_b64_tr_b16 v[40:41], v13 offset:12352
    ds_read_b64_tr_b16 v[42:43], v13 offset:13120
    s_add_u32 s38, s32, 7168
    buffer_load_dwordx4 v21, s[16:19], s38 offen offset:1024 lds
    v_mfma_f32_32x32x16_bf16 v[168:183], v[48:51], v[68:71], v[168:183]
    ds_read_b128 v[88:91], v9 offset:16384
    ds_read_b128 v[92:95], v9 offset:20480
    v_mfma_f32_32x32x16_bf16 v[184:199], v[52:55], v[64:67], v[184:199]
    ds_read_b128 v[96:99], v10 offset:16384
    s_add_u32 s38, s32, 14336
    buffer_load_dwordx4 v20, s[16:19], s38 offen offset:2048 lds
    v_mfma_f32_32x32x16_bf16 v[200:215], v[52:55], v[68:71], v[200:215]
    ds_read_b128 v[100:103], v10 offset:20480
    s_add_u32 s38, s32, 21504
    buffer_load_dwordx4 v21, s[16:19], s38 offen offset:3072 lds
    s_waitcnt lgkmcnt(8)
    v_mfma_f32_32x32x16_bf16 v[120:135], v[32:35], v[72:75], v[120:135]
    ds_read_b64_tr_b16 v[44:45], v15 offset:12288
    ds_read_b64_tr_b16 v[46:47], v15 offset:13056
    v_mfma_f32_32x32x16_bf16 v[136:151], v[32:35], v[76:79], v[136:151]
    ds_read_b64_tr_b16 v[48:49], v16 offset:12288
    ds_read_b64_tr_b16 v[50:51], v16 offset:13056
    v_mfma_f32_16x16x32_bf16 v[216:219], v[24:27], v[32:35], v[216:219]
    s_add_u32 s48, s48, 88064
    s_cmp_ge_u32 s48, s49
    s_cselect_b32 s38, 1409024, 0
    s_sub_u32 s48, s48, s38
    s_add_u32 m0, s43, 32768
    s_nop 0
    buffer_load_dwordx4 v17, s[52:55], s48 offen offset:0 lds
    s_waitcnt lgkmcnt(10)
    v_mfma_f32_32x32x16_bf16 v[152:167], v[36:39], v[72:75], v[152:167]
    ds_read_b64_tr_b16 v[52:53], v15 offset:12352
    ds_read_b64_tr_b16 v[54:55], v15 offset:13120
    v_mfma_f32_32x32x16_bf16 v[168:183], v[36:39], v[76:79], v[168:183]
    ds_read_b128 v[104:107], v11 offset:16384
    ds_read_b128 v[108:111], v11 offset:20480
    v_mfma_f32_16x16x32_bf16 v[220:223], v[24:27], v[36:39], v[220:223]
    buffer_load_dwordx4 v18, s[52:55], s48 offen offset:1024 lds
    s_waitcnt lgkmcnt(12)
    v_mfma_f32_32x32x16_bf16 v[184:199], v[40:43], v[72:75], v[184:199]
    ds_read_b128 v[112:115], v12 offset:16384
    v_mfma_f32_32x32x16_bf16 v[200:215], v[40:43], v[76:79], v[200:215]
    ds_read_b128 v[116:119], v12 offset:20480
    v_mfma_f32_16x16x32_bf16 v[224:227], v[24:27], v[40:43], v[224:227]
    buffer_load_dwordx4 v19, s[52:55], s48 offen offset:2048 lds
    s_waitcnt vmcnt(11)
    s_waitcnt lgkmcnt(0)
    s_barrier
    v_mfma_f32_32x32x16_bf16 v[120:135], v[44:47], v[80:83], v[120:135]
    ds_read_b64_tr_b16 v[32:33], v13 offset:24576
    ds_read_b64_tr_b16 v[34:35], v13 offset:25344
    v_mfma_f32_32x32x16_bf16 v[136:151], v[44:47], v[84:87], v[136:151]
    ds_read_b64_tr_b16 v[36:37], v14 offset:24576
    ds_read_b64_tr_b16 v[38:39], v14 offset:25344
    s_add_u32 s48, s48, 88064
    s_cmp_ge_u32 s48, s49
    s_cselect_b32 s38, 1409024, 0
    s_sub_u32 s48, s48, s38
    s_add_u32 m0, s43, 45056
    s_nop 0
    buffer_load_dwordx4 v17, s[52:55], s48 offen offset:0 lds
    v_mfma_f32_32x32x16_bf16 v[152:167], v[48:51], v[80:83], v[152:167]
    ds_read_b64_tr_b16 v[40:41], v13 offset:24640
    ds_read_b64_tr_b16 v[42:43], v13 offset:25408
    buffer_load_dwordx4 v18, s[52:55], s48 offen offset:1024 lds
    v_mfma_f32_32x32x16_bf16 v[168:183], v[48:51], v[84:87], v[168:183]
    v_mfma_f32_32x32x16_bf16 v[184:199], v[52:55], v[80:83], v[184:199]
    buffer_load_dwordx4 v19, s[52:55], s48 offen offset:2048 lds
    v_mfma_f32_32x32x16_bf16 v[200:215], v[52:55], v[84:87], v[200:215]
    s_add_u32 s32, s32, 128
    s_bitset0_b32 s32, 10
    s_add_u32 m0, s7, 16384
    s_nop 0
    buffer_load_dwordx4 v20, s[16:19], s32 offen offset:0 lds
    s_waitcnt lgkmcnt(4)
    v_mfma_f32_32x32x16_bf16 v[120:135], v[32:35], v[88:91], v[120:135]
    ds_read_b64_tr_b16 v[44:45], v15 offset:24576
    ds_read_b64_tr_b16 v[46:47], v15 offset:25344
    v_mfma_f32_32x32x16_bf16 v[136:151], v[32:35], v[92:95], v[136:151]
    ds_read_b64_tr_b16 v[48:49], v16 offset:24576
    ds_read_b64_tr_b16 v[50:51], v16 offset:25344
    v_mfma_f32_16x16x32_bf16 v[216:219], v[24:27], v[32:35], v[216:219]
    s_add_u32 s38, s32, 7168
    buffer_load_dwordx4 v21, s[16:19], s38 offen offset:1024 lds
    s_waitcnt lgkmcnt(6)
    v_mfma_f32_32x32x16_bf16 v[152:167], v[36:39], v[88:91], v[152:167]
    ds_read_b64_tr_b16 v[52:53], v15 offset:24640
    ds_read_b64_tr_b16 v[54:55], v15 offset:25408
    v_mfma_f32_32x32x16_bf16 v[168:183], v[36:39], v[92:95], v[168:183]
    v_mfma_f32_16x16x32_bf16 v[220:223], v[24:27], v[36:39], v[220:223]
    s_add_u32 s38, s32, 14336
    buffer_load_dwordx4 v20, s[16:19], s38 offen offset:2048 lds
    s_waitcnt lgkmcnt(6)
    v_mfma_f32_32x32x16_bf16 v[184:199], v[40:43], v[88:91], v[184:199]
    v_mfma_f32_32x32x16_bf16 v[200:215], v[40:43], v[92:95], v[200:215]
    v_mfma_f32_16x16x32_bf16 v[224:227], v[24:27], v[40:43], v[224:227]
    s_add_u32 s38, s32, 21504
    buffer_load_dwordx4 v21, s[16:19], s38 offen offset:3072 lds
    s_waitcnt vmcnt(15)
    s_waitcnt vmcnt(10)
    s_waitcnt lgkmcnt(0)
    s_barrier
    v_mfma_f32_32x32x16_bf16 v[120:135], v[44:47], v[96:99], v[120:135]
    ds_read_b64_tr_b16 v[32:33], v13 offset:36864
    ds_read_b64_tr_b16 v[34:35], v13 offset:37632
    v_mfma_f32_32x32x16_bf16 v[136:151], v[44:47], v[100:103], v[136:151]
    ds_read_b64_tr_b16 v[36:37], v14 offset:36864
    ds_read_b64_tr_b16 v[38:39], v14 offset:37632
    v_mfma_f32_32x32x16_bf16 v[152:167], v[48:51], v[96:99], v[152:167]
    ds_read_b64_tr_b16 v[40:41], v13 offset:36928
    ds_read_b64_tr_b16 v[42:43], v13 offset:37696
    s_add_u32 s48, s48, 88064
    s_cmp_ge_u32 s48, s49
    s_cselect_b32 s38, 1409024, 0
    s_sub_u32 s48, s48, s38
    s_add_u32 m0, s43, 57344
    s_nop 0
    buffer_load_dwordx4 v17, s[52:55], s48 offen offset:0 lds
    v_mfma_f32_32x32x16_bf16 v[168:183], v[48:51], v[100:103], v[168:183]
    ds_read_b128 v[56:59], v9 offset:0
    ds_read_b128 v[60:63], v9 offset:4096
    v_mfma_f32_32x32x16_bf16 v[184:199], v[52:55], v[96:99], v[184:199]
    ds_read_b128 v[64:67], v10 offset:0
    v_mfma_f32_32x32x16_bf16 v[200:215], v[52:55], v[100:103], v[200:215]
    ds_read_b128 v[68:71], v10 offset:4096
    buffer_load_dwordx4 v18, s[52:55], s48 offen offset:1024 lds
    s_waitcnt lgkmcnt(8)
    v_mfma_f32_32x32x16_bf16 v[120:135], v[32:35], v[104:107], v[120:135]
    ds_read_b64_tr_b16 v[44:45], v15 offset:36864
    ds_read_b64_tr_b16 v[46:47], v15 offset:37632
    v_mfma_f32_32x32x16_bf16 v[136:151], v[32:35], v[108:111], v[136:151]
    ds_read_b64_tr_b16 v[48:49], v16 offset:36864
    ds_read_b64_tr_b16 v[50:51], v16 offset:37632
    v_mfma_f32_16x16x32_bf16 v[216:219], v[24:27], v[32:35], v[216:219]
    s_waitcnt lgkmcnt(10)
    v_mfma_f32_32x32x16_bf16 v[152:167], v[36:39], v[104:107], v[152:167]
    ds_read_b64_tr_b16 v[52:53], v15 offset:36928
    ds_read_b64_tr_b16 v[54:55], v15 offset:37696
    v_mfma_f32_32x32x16_bf16 v[168:183], v[36:39], v[108:111], v[168:183]
    ds_read_b128 v[72:75], v11 offset:0
    ds_read_b128 v[76:79], v11 offset:4096
    v_mfma_f32_16x16x32_bf16 v[220:223], v[24:27], v[36:39], v[220:223]
    s_waitcnt lgkmcnt(12)
    v_mfma_f32_32x32x16_bf16 v[184:199], v[40:43], v[104:107], v[184:199]
    ds_read_b128 v[80:83], v12 offset:0
    v_mfma_f32_32x32x16_bf16 v[200:215], v[40:43], v[108:111], v[200:215]
    ds_read_b128 v[84:87], v12 offset:4096
    v_mfma_f32_16x16x32_bf16 v[224:227], v[24:27], v[40:43], v[224:227]
    buffer_load_dwordx4 v19, s[52:55], s48 offen offset:2048 lds
    s_mov_b32 s92, 200000
tok_l1:
    v_readfirstlane_b32 s90, v252
    v_readfirstlane_b32 s91, v253
    s_cmp_lg_u32 s90, 0
    s_cbranch_scc1 tok_d1
    buffer_load_dwordx2 v[252:253], off, s[60:63], 0 sc0 sc1
    s_waitcnt vmcnt(0)
    s_sub_u32 s92, s92, 1
    s_cmp_lg_u32 s92, 0
    s_cbranch_scc1 tok_l1
tok_d1:
    v_mov_b32 v230, s90
    v_mov_b32 v231, s91
    v_lshrrev_b32 v2, 1, v1
    s_mov_b32 exec_lo, 1
    s_mov_b32 exec_hi, 1
    buffer_store_dwordx4 v[228:231], v2, s[12:15], s35 offen sc0 sc1
    s_mov_b64 exec, -1
    s_waitcnt vmcnt(11)
    s_waitcnt lgkmcnt(0)
    s_barrier
    v_mfma_f32_32x32x16_bf16 v[120:135], v[44:47], v[112:115], v[120:135]
    ds_read_b64_tr_b16 v[32:33], v13 offset:0
    ds_read_b64_tr_b16 v[34:35], v13 offset:768
    v_mfma_f32_32x32x16_bf16 v[136:151], v[44:47], v[116:119], v[136:151]
    ds_read_b64_tr_b16 v[36:37], v14 offset:0
    ds_read_b64_tr_b16 v[38:39], v14 offset:768
    s_add_u32 s48, s48, 88064
    s_cmp_ge_u32 s48, s49
    s_cselect_b32 s38, 1409024, 0
    s_sub_u32 s48, s48, s38
    s_add_u32 m0, s43, 69632
    s_nop 0
    buffer_load_dwordx4 v17, s[52:55], s48 offen offset:0 lds
    v_mfma_f32_32x32x16_bf16 v[152:167], v[48:51], v[112:115], v[152:167]
    ds_read_b64_tr_b16 v[40:41], v13 offset:64
    ds_read_b64_tr_b16 v[42:43], v13 offset:832
    buffer_load_dwordx4 v18, s[52:55], s48 offen offset:1024 lds
    v_mfma_f32_32x32x16_bf16 v[168:183], v[48:51], v[116:119], v[168:183]
    v_mfma_f32_32x32x16_bf16 v[184:199], v[52:55], v[112:115], v[184:199]
    buffer_load_dwordx4 v19, s[52:55], s48 offen offset:2048 lds
    v_mfma_f32_32x32x16_bf16 v[200:215], v[52:55], v[116:119], v[200:215]
    s_add_u32 s32, s32, 128
    s_bitset0_b32 s32, 10
    s_add_u32 m0, s7, 0
    s_nop 0
    buffer_load_dwordx4 v20, s[16:19], s32 offen offset:0 lds
    s_waitcnt lgkmcnt(4)
    v_mfma_f32_32x32x16_bf16 v[120:135], v[32:35], v[56:59], v[120:135]
    ds_read_b64_tr_b16 v[44:45], v15 offset:0
    ds_read_b64_tr_b16 v[46:47], v15 offset:768
    v_mfma_f32_32x32x16_bf16 v[136:151], v[32:35], v[60:63], v[136:151]
    ds_read_b64_tr_b16 v[48:49], v16 offset:0
    ds_read_b64_tr_b16 v[50:51], v16 offset:768
    v_mfma_f32_16x16x32_bf16 v[216:219], v[24:27], v[32:35], v[216:219]
    s_add_u32 s38, s32, 7168
    buffer_load_dwordx4 v21, s[16:19], s38 offen offset:1024 lds
    s_waitcnt lgkmcnt(6)
    v_mfma_f32_32x32x16_bf16 v[152:167], v[36:39], v[56:59], v[152:167]
    ds_read_b64_tr_b16 v[52:53], v15 offset:64
    ds_read_b64_tr_b16 v[54:55], v15 offset:832
    v_mfma_f32_32x32x16_bf16 v[168:183], v[36:39], v[60:63], v[168:183]
    v_mfma_f32_16x16x32_bf16 v[220:223], v[24:27], v[36:39], v[220:223]
    s_add_u32 s38, s32, 14336
    buffer_load_dwordx4 v20, s[16:19], s38 offen offset:2048 lds
    s_waitcnt lgkmcnt(6)
    v_mfma_f32_32x32x16_bf16 v[184:199], v[40:43], v[56:59], v[184:199]
    v_mfma_f32_32x32x16_bf16 v[200:215], v[40:43], v[60:63], v[200:215]
    v_mfma_f32_16x16x32_bf16 v[224:227], v[24:27], v[40:43], v[224:227]
    s_add_u32 s38, s32, 21504
    buffer_load_dwordx4 v21, s[16:19], s38 offen offset:3072 lds
    s_waitcnt vmcnt(15)
    s_waitcnt vmcnt(11)
    s_waitcnt lgkmcnt(0)
    s_barrier
    v_mfma_f32_32x32x16_bf16 v[120:135], v[44:47], v[64:67], v[120:135]
    ds_read_b64_tr_b16 v[32:33], v13 offset:12288
    ds_read_b64_tr_b16 v[34:35], v13 offset:13056
    v_mfma_f32_32x32x16_bf16 v[136:151], v[44:47], v[68:71], v[136:151]
    ds_read_b64_tr_b16 v[36:37], v14 offset:12288
    ds_read_b64_tr_b16 v[38:39], v14 offset:13056
    v_mfma_f32_32x32x16_bf16 v[152:167], v[48:51], v[64:67], v[152:167]
    ds_read_b64_tr_b16 v[40:41], v13 offset:12352
    ds_read_b64_tr_b16 v[42:43], v13 offset:13120
    s_add_u32 s48, s48, 88064
    s_cmp_ge_u32 s48, s49
    s_cselect_b32 s38, 1409024, 0
    s_sub_u32 s48, s48, s38
    s_add_u32 m0, s43, 32768
    s_nop 0
    buffer_load_dwordx4 v17, s[52:55], s48 offen offset:0 lds
    v_mfma_f32_32x32x16_bf16 v[168:183], v[48:51], v[68:71], v[168:183]
    ds_read_b128 v[88:91], v9 offset:16384
    ds_read_b128 v[92:95], v9 offset:20480
    v_mfma_f32_32x32x16_bf16 v[184:199], v[52:55], v[64:67], v[184:199]
    ds_read_b128 v[96:99], v10 offset:16384
    v_mfma_f32_32x32x16_bf16 v[200:215], v[52:55], v[68:71], v[200:215]
    ds_read_b128 v[100:103], v10 offset:20480
    buffer_load_dwordx4 v18, s[52:55], s48 offen offset:1024 lds
    s_waitcnt lgkmcnt(8)
    v_mfma_f32_32x32x16_bf16 v[120:135], v[32:35], v[72:75], v[120:135]
    ds_read_b64_tr_b16 v[44:45], v15 offset:12288
    ds_read_b64_tr_b16 v[46:47], v15 offset:13056
    v_mfma_f32_32x32x16_bf16 v[136:151], v[32:35], v[76:79], v[136:151]
    ds_read_b64_tr_b16 v[48:49], v16 offset:12288
    ds_read_b64_tr_b16 v[50:51], v16 offset:13056
    v_mfma_f32_16x16x32_bf16 v[216:219], v[24:27], v[32:35], v[216:219]
    s_waitcnt lgkmcnt(10)
    v_mfma_f32_32x32x16_bf16 v[152:167], v[36:39], v[72:75], v[152:167]
    ds_read_b64_tr_b16 v[52:53], v15 offset:12352
    ds_read_b64_tr_b16 v[54:55], v15 offset:13120
    v_mfma_f32_32x32x16_bf16 v[168:183], v[36:39], v[76:79], v[168:183]
    ds_read_b128 v[104:107], v11 offset:16384
    ds_read_b128 v[108:111], v11 offset:20480
    v_mfma_f32_16x16x32_bf16 v[220:223], v[24:27], v[36:39], v[220:223]
    s_waitcnt lgkmcnt(12)
    v_mfma_f32_32x32x16_bf16 v[184:199], v[40:43], v[72:75], v[184:199]
    ds_read_b128 v[112:115], v12 offset:16384
    v_mfma_f32_32x32x16_bf16 v[200:215], v[40:43], v[76:79], v[200:215]
    ds_read_b128 v[116:119], v12 offset:20480
    v_mfma_f32_16x16x32_bf16 v[224:227], v[24:27], v[40:43], v[224:227]
    buffer_load_dwordx4 v19, s[52:55], s48 offen offset:2048 lds
    s_waitcnt vmcnt(11)
    s_waitcnt lgkmcnt(0)
    s_barrier
    v_mfma_f32_32x32x16_bf16 v[120:135], v[44:47], v[80:83], v[120:135]
    ds_read_b64_tr_b16 v[32:33], v13 offset:24576
    ds_read_b64_tr_b16 v[34:35], v13 offset:25344
    v_mfma_f32_32x32x16_bf16 v[136:151], v[44:47], v[84:87], v[136:151]
    ds_read_b64_tr_b16 v[36:37], v14 offset:24576
    ds_read_b64_tr_b16 v[38:39], v14 offset:25344
    s_add_u32 s48, s48, 88064
    s_cmp_ge_u32 s48, s49
    s_cselect_b32 s38, 1409024, 0
    s_sub_u32 s48, s48, s38
    s_add_u32 m0, s43, 45056
    s_nop 0
    buffer_load_dwordx4 v17, s[52:55], s48 offen offset:0 lds
    v_mfma_f32_32x32x16_bf16 v[152:167], v[48:51], v[80:83], v[152:167]
    ds_read_b64_tr_b16 v[40:41], v13 offset:24640
    ds_read_b64_tr_b16 v[42:43], v13 offset:25408
    buffer_load_dwordx4 v18, s[52:55], s48 offen offset:1024 lds
    v_mfma_f32_32x32x16_bf16 v[168:183], v[48:51], v[84:87], v[168:183]
    v_mfma_f32_32x32x16_bf16 v[184:199], v[52:55], v[80:83], v[184:199]
    buffer_load_dwordx4 v19, s[52:55], s48 offen offset:2048 lds
    v_mfma_f32_32x32x16_bf16 v[200:215], v[52:55], v[84:87], v[200:215]
    s_add_u32 s32, s32, 128
    s_bitset0_b32 s32, 10
    s_add_u32 m0, s7, 16384
    s_nop 0
    buffer_load_dwordx4 v20, s[16:19], s32 offen offset:0 lds
    s_waitcnt lgkmcnt(4)
    v_mfma_f32_32x32x16_bf16 v[120:135], v[32:35], v[88:91], v[120:135]
    ds_read_b64_tr_b16 v[44:45], v15 offset:24576
    ds_read_b64_tr_b16 v[46:47], v15 offset:25344
    v_mfma_f32_32x32x16_bf16 v[136:151], v[32:35], v[92:95], v[136:151]
    ds_read_b64_tr_b16 v[48:49], v16 offset:24576
    ds_read_b64_tr_b16 v[50:51], v16 offset:25344
    v_mfma_f32_16x16x32_bf16 v[216:219], v[24:27], v[32:35], v[216:219]
    s_add_u32 s38, s32, 7168
    buffer_load_dwordx4 v21, s[16:19], s38 offen offset:1024 lds
    s_waitcnt lgkmcnt(6)
    v_mfma_f32_32x32x16_bf16 v[152:167], v[36:39], v[88:91], v[152:167]
    ds_read_b64_tr_b16 v[52:53], v15 offset:24640
    ds_read_b64_tr_b16 v[54:55], v15 offset:25408
    v_mfma_f32_32x32x16_bf16 v[168:183], v[36:39], v[92:95], v[168:183]
    v_mfma_f32_16x16x32_bf16 v[220:223], v[24:27], v[36:39], v[220:223]
    s_add_u32 s38, s32, 14336
    buffer_load_dwordx4 v20, s[16:19], s38 offen offset:2048 lds
    s_waitcnt lgkmcnt(6)
    v_mfma_f32_32x32x16_bf16 v[184:199], v[40:43], v[88:91], v[184:199]
    v_mfma_f32_32x32x16_bf16 v[200:215], v[40:43], v[92:95], v[200:215]
    v_mfma_f32_16x16x32_bf16 v[224:227], v[24:27], v[40:43], v[224:227]
    s_add_u32 s38, s32, 21504
    buffer_load_dwordx4 v21, s[16:19], s38 offen offset:3072 lds
    s_waitcnt vmcnt(14)
    s_waitcnt vmcnt(10)
    s_waitcnt lgkmcnt(0)
    s_barrier
    v_mfma_f32_32x32x16_bf16 v[120:135], v[44:47], v[96:99], v[120:135]
    ds_read_b64_tr_b16 v[32:33], v13 offset:36864
    ds_read_b64_tr_b16 v[34:35], v13 offset:37632
    v_mfma_f32_32x32x16_bf16 v[136:151], v[44:47], v[100:103], v[136:151]
    ds_read_b64_tr_b16 v[36:37], v14 offset:36864
    ds_read_b64_tr_b16 v[38:39], v14 offset:37632
    v_mfma_f32_32x32x16_bf16 v[152:167], v[48:51], v[96:99], v[152:167]
    ds_read_b64_tr_b16 v[40:41], v13 offset:36928
    ds_read_b64_tr_b16 v[42:43], v13 offset:37696
    s_add_u32 s48, s48, 88064
    s_cmp_ge_u32 s48, s49
    s_cselect_b32 s38, 1409024, 0
    s_sub_u32 s48, s48, s38
    s_add_u32 m0, s43, 57344
    s_nop 0
    buffer_load_dwordx4 v17, s[52:55], s48 offen offset:0 lds
    v_mfma_f32_32x32x16_bf16 v[168:183], v[48:51], v[100:103], v[168:183]
    ds_read_b128 v[56:59], v9 offset:0
    ds_read_b128 v[60:63], v9 offset:4096
    v_mfma_f32_32x32x16_bf16 v[184:199], v[52:55], v[96:99], v[184:199]
    ds_read_b128 v[64:67], v10 offset:0
    v_mfma_f32_32x32x16_bf16 v[200:215], v[52:55], v[100:103], v[200:215]
    ds_read_b128 v[68:71], v10 offset:4096
    buffer_load_dwordx4 v18, s[52:55], s48 offen offset:1024 lds
    s_waitcnt lgkmcnt(8)
    v_mfma_f32_32x32x16_bf16 v[120:135], v[32:35], v[104:107], v[120:135]
    ds_read_b64_tr_b16 v[44:45], v15 offset:36864
    ds_read_b64_tr_b16 v[46:47], v15 offset:37632
    v_mfma_f32_32x32x16_bf16 v[136:151], v[32:35], v[108:111], v[136:151]
    ds_read_b64_tr_b16 v[48:49], v16 offset:36864
    ds_read_b64_tr_b16 v[50:51], v16 offset:37632
    v_mfma_f32_16x16x32_bf16 v[216:219], v[24:27], v[32:35], v[216:219]
    s_waitcnt lgkmcnt(10)
    v_mfma_f32_32x32x16_bf16 v[152:167], v[36:39], v[104:107], v[152:167]
    ds_read_b64_tr_b16 v[52:53], v15 offset:36928
    ds_read_b64_tr_b16 v[54:55], v15 offset:37696
    v_mfma_f32_32x32x16_bf16 v[168:183], v[36:39], v[108:111], v[168:183]
    ds_read_b128 v[72:75], v11 offset:0
    ds_read_b128 v[76:79], v11 offset:4096
    v_mfma_f32_16x16x32_bf16 v[220:223], v[24:27], v[36:39], v[220:223]
    s_waitcnt lgkmcnt(12)
    v_mfma_f32_32x32x16_bf16 v[184:199], v[40:43], v[104:107], v[184:199]
    ds_read_b128 v[80:83], v12 offset:0
    v_mfma_f32_32x32x16_bf16 v[200:215], v[40:43], v[108:111], v[200:215]
    ds_read_b128 v[84:87], v12 offset:4096
    v_mfma_f32_16x16x32_bf16 v[224:227], v[24:27], v[40:43], v[224:227]
    buffer_load_dwordx4 v19, s[52:55], s48 offen offset:2048 lds
    s_waitcnt vmcnt(10)
    s_waitcnt lgkmcnt(0)
    s_barrier
    v_mfma_f32_32x32x16_bf16 v[120:135], v[44:47], v[112:115], v[120:135]
    ds_read_b64_tr_b16 v[32:33], v13 offset:0
    ds_read_b64_tr_b16 v[34:35], v13 offset:768
    v_mfma_f32_32x32x16_bf16 v[136:151], v[44:47], v[116:119], v[136:151]
    ds_read_b64_tr_b16 v[36:37], v14 offset:0
    ds_read_b64_tr_b16 v[38:39], v14 offset:768
    s_add_u32 s48, s48, 88064
    s_cmp_ge_u32 s48, s49
    s_cselect_b32 s38, 1409024, 0
    s_sub_u32 s48, s48, s38
    s_add_u32 m0, s43, 69632
    s_nop 0
    buffer_load_dwordx4 v17, s[52:55], s48 offen offset:0 lds
    v_mfma_f32_32x32x16_bf16 v[152:167], v[48:51], v[112:115], v[152:167]
    ds_read_b64_tr_b16 v[40:41], v13 offset:64
    ds_read_b64_tr_b16 v[42:43], v13 offset:832
    buffer_load_dwordx4 v18, s[52:55], s48 offen offset:1024 lds
    v_mfma_f32_32x32x16_bf16 v[168:183], v[48:51], v[116:119], v[168:183]
    v_mfma_f32_32x32x16_bf16 v[184:199], v[52:55], v[112:115], v[184:199]
    buffer_load_dwordx4 v19, s[52:55], s48 offen offset:2048 lds
    v_mfma_f32_32x32x16_bf16 v[200:215], v[52:55], v[116:119], v[200:215]
    s_add_u32 s32, s32, 128
    s_bitset0_b32 s32, 10
    s_add_u32 m0, s7, 0
    s_nop 0
    buffer_load_dwordx4 v20, s[16:19], s32 offen offset:0 lds
    s_waitcnt lgkmcnt(4)
    v_mfma_f32_32x32x16_bf16 v[120:135], v[32:35], v[56:59], v[120:135]
    ds_read_b64_tr_b16 v[44:45], v15 offset:0
    ds_read_b64_tr_b16 v[46:47], v15 offset:768
    v_mfma_f32_32x32x16_bf16 v[136:151], v[32:35], v[60:63], v[136:151]
    ds_read_b64_tr_b16 v[48:49], v16 offset:0
    ds_read_b64_tr_b16 v[50:51], v16 offset:768
    v_mfma_f32_16x16x32_bf16 v[216:219], v[24:27], v[32:35], v[216:219]
    s_add_u32 s38, s32, 7168
    buffer_load_dwordx4 v21, s[16:19], s38 offen offset:1024 lds
    s_waitcnt lgkmcnt(6)
    v_mfma_f32_32x32x16_bf16 v[152:167], v[36:39], v[56:59], v[152:167]
    ds_read_b64_tr_b16 v[52:53], v15 offset:64
    ds_read_b64_tr_b16 v[54:55], v15 offset:832
    v_mfma_f32_32x32x16_bf16 v[168:183], v[36:39], v[60:63], v[168:183]
    v_mfma_f32_16x16x32_bf16 v[220:223], v[24:27], v[36:39], v[220:223]
    s_add_u32 s38, s32, 14336
    buffer_load_dwordx4 v20, s[16:19], s38 offen offset:2048 lds
    s_waitcnt lgkmcnt(6)
    v_mfma_f32_32x32x16_bf16 v[184:199], v[40:43], v[56:59], v[184:199]
    v_mfma_f32_32x32x16_bf16 v[200:215], v[40:43], v[60:63], v[200:215]
    v_mfma_f32_16x16x32_bf16 v[224:227], v[24:27], v[40:43], v[224:227]
    s_add_u32 s38, s32, 21504
    buffer_load_dwordx4 v21, s[16:19], s38 offen offset:3072 lds
    s_waitcnt vmcnt(14)
    s_waitcnt vmcnt(10)
    s_waitcnt lgkmcnt(0)
    s_barrier
    v_mfma_f32_32x32x16_bf16 v[120:135], v[44:47], v[64:67], v[120:135]
    ds_read_b64_tr_b16 v[32:33], v13 offset:12288
    ds_read_b64_tr_b16 v[34:35], v13 offset:13056
    v_mfma_f32_32x32x16_bf16 v[136:151], v[44:47], v[68:71], v[136:151]
    ds_read_b64_tr_b16 v[36:37], v14 offset:12288
    ds_read_b64_tr_b16 v[38:39], v14 offset:13056
    v_mfma_f32_32x32x16_bf16 v[152:167], v[48:51], v[64:67], v[152:167]
    ds_read_b64_tr_b16 v[40:41], v13 offset:12352
    ds_read_b64_tr_b16 v[42:43], v13 offset:13120
    s_add_u32 s48, s48, 88064
    s_cmp_ge_u32 s48, s49
    s_cselect_b32 s38, 1409024, 0
    s_sub_u32 s48, s48, s38
    s_add_u32 m0, s43, 32768
    s_nop 0
    buffer_load_dwordx4 v17, s[52:55], s48 offen offset:0 lds
    v_mfma_f32_32x32x16_bf16 v[168:183], v[48:51], v[68:71], v[168:183]
    ds_read_b128 v[88:91], v9 offset:16384
    ds_read_b128 v[92:95], v9 offset:20480
    v_mfma_f32_32x32x16_bf16 v[184:199], v[52:55], v[64:67], v[184:199]
    ds_read_b128 v[96:99], v10 offset:16384
    v_mfma_f32_32x32x16_bf16 v[200:215], v[52:55], v[68:71], v[200:215]
    ds_read_b128 v[100:103], v10 offset:20480
    buffer_load_dwordx4 v18, s[52:55], s48 offen offset:1024 lds
    s_waitcnt lgkmcnt(8)
    v_mfma_f32_32x32x16_bf16 v[120:135], v[32:35], v[72:75], v[120:135]
    ds_read_b64_tr_b16 v[44:45], v15 offset:12288
    ds_read_b64_tr_b16 v[46:47], v15 offset:13056
    v_mfma_f32_32x32x16_bf16 v[136:151], v[32:35], v[76:79], v[136:151]
    ds_read_b64_tr_b16 v[48:49], v16 offset:12288
    ds_read_b64_tr_b16 v[50:51], v16 offset:13056
    v_mfma_f32_16x16x32_bf16 v[216:219], v[24:27], v[32:35], v[216:219]
    s_waitcnt lgkmcnt(10)
    v_mfma_f32_32x32x16_bf16 v[152:167], v[36:39], v[72:75], v[152:167]
    ds_read_b64_tr_b16 v[52:53], v15 offset:12352
    ds_read_b64_tr_b16 v[54:55], v15 offset:13120
    v_mfma_f32_32x32x16_bf16 v[168:183], v[36:39], v[76:79], v[168:183]
    ds_read_b128 v[104:107], v11 offset:16384
    ds_read_b128 v[108:111], v11 offset:20480
    v_mfma_f32_16x16x32_bf16 v[220:223], v[24:27], v[36:39], v[220:223]
    s_waitcnt lgkmcnt(12)
    v_mfma_f32_32x32x16_bf16 v[184:199], v[40:43], v[72:75], v[184:199]
    ds_read_b128 v[112:115], v12 offset:16384
    v_mfma_f32_32x32x16_bf16 v[200:215], v[40:43], v[76:79], v[200:215]
    ds_read_b128 v[116:119], v12 offset:20480
    v_mfma_f32_16x16x32_bf16 v[224:227], v[24:27], v[40:43], v[224:227]
    buffer_load_dwordx4 v19, s[52:55], s48 offen offset:2048 lds
    s_waitcnt vmcnt(10)
    s_waitcnt lgkmcnt(0)
    s_barrier
    v_mfma_f32_32x32x16_bf16 v[120:135], v[44:47], v[80:83], v[120:135]
    ds_read_b64_tr_b16 v[32:33], v13 offset:24576
    ds_read_b64_tr_b16 v[34:35], v13 offset:25344
    v_mfma_f32_32x32x16_bf16 v[136:151], v[44:47], v[84:87], v[136:151]
    ds_read_b64_tr_b16 v[36:37], v14 offset:24576
    ds_read_b64_tr_b16 v[38:39], v14 offset:25344
    s_add_u32 s48, s48, 88064
    s_cmp_ge_u32 s48, s49
    s_cselect_b32 s38, 1409024, 0
    s_sub_u32 s48, s48, s38
    s_add_u32 m0, s43, 45056
    s_nop 0
    buffer_load_dwordx4 v17, s[52:55], s48 offen offset:0 lds
    v_mfma_f32_32x32x16_bf16 v[152:167], v[48:51], v[80:83], v[152:167]
    ds_read_b64_tr_b16 v[40:41], v13 offset:24640
    ds_read_b64_tr_b16 v[42:43], v13 offset:25408
    buffer_load_dwordx4 v18, s[52:55], s48 offen offset:1024 lds
    v_mfma_f32_32x32x16_bf16 v[168:183], v[48:51], v[84:87], v[168:183]
    v_mfma_f32_32x32x16_bf16 v[184:199], v[52:55], v[80:83], v[184:199]
    buffer_load_dwordx4 v19, s[52:55], s48 offen offset:2048 lds
    v_mfma_f32_32x32x16_bf16 v[200:215], v[52:55], v[84:87], v[200:215]
    s_add_u32 s32, s32, 128
    s_bitset0_b32 s32, 10
    s_add_u32 m0, s7, 16384
    s_nop 0
    buffer_load_dwordx4 v20, s[16:19], s32 offen offset:0 lds
    s_waitcnt lgkmcnt(4)
    v_mfma_f32_32x32x16_bf16 v[120:135], v[32:35], v[88:91], v[120:135]
    ds_read_b64_tr_b16 v[44:45], v15 offset:24576
    ds_read_b64_tr_b16 v[46:47], v15 offset:25344
    v_mfma_f32_32x32x16_bf16 v[136:151], v[32:35], v[92:95], v[136:151]
    ds_read_b64_tr_b16 v[48:49], v16 offset:24576
    ds_read_b64_tr_b16 v[50:51], v16 offset:25344
    v_mfma_f32_16x16x32_bf16 v[216:219], v[24:27], v[32:35], v[216:219]
    s_add_u32 s38, s32, 7168
    buffer_load_dwordx4 v21, s[16:19], s38 offen offset:1024 lds
    s_waitcnt lgkmcnt(6)
    v_mfma_f32_32x32x16_bf16 v[152:167], v[36:39], v[88:91], v[152:167]
    ds_read_b64_tr_b16 v[52:53], v15 offset:24640
    ds_read_b64_tr_b16 v[54:55], v15 offset:25408
    v_mfma_f32_32x32x16_bf16 v[168:183], v[36:39], v[92:95], v[168:183]
    v_mfma_f32_16x16x32_bf16 v[220:223], v[24:27], v[36:39], v[220:223]
    s_add_u32 s38, s32, 14336
    buffer_load_dwordx4 v20, s[16:19], s38 offen offset:2048 lds
    s_waitcnt lgkmcnt(6)
    v_mfma_f32_32x32x16_bf16 v[184:199], v[40:43], v[88:91], v[184:199]
    v_mfma_f32_32x32x16_bf16 v[200:215], v[40:43], v[92:95], v[200:215]
    v_mfma_f32_16x16x32_bf16 v[224:227], v[24:27], v[40:43], v[224:227]
    s_add_u32 s38, s32, 21504
    buffer_load_dwordx4 v21, s[16:19], s38 offen offset:3072 lds
    buffer_load_dwordx2 v[232:233], v23, s[16:19], 0 offen offset:0
    buffer_load_dwordx2 v[234:235], v23, s[16:19], 0 offen offset:16
    buffer_load_dwordx2 v[236:237], v23, s[16:19], 0 offen offset:32
    buffer_load_dwordx2 v[238:239], v23, s[16:19], 0 offen offset:48
    s_waitcnt vmcnt(18)
    s_waitcnt vmcnt(14)
    s_waitcnt lgkmcnt(0)
    s_barrier
    v_mfma_f32_32x32x16_bf16 v[120:135], v[44:47], v[96:99], v[120:135]
    ds_read_b64_tr_b16 v[32:33], v13 offset:36864
    ds_read_b64_tr_b16 v[34:35], v13 offset:37632
    v_mfma_f32_32x32x16_bf16 v[136:151], v[44:47], v[100:103], v[136:151]
    ds_read_b64_tr_b16 v[36:37], v14 offset:36864
    ds_read_b64_tr_b16 v[38:39], v14 offset:37632
    v_mfma_f32_32x32x16_bf16 v[152:167], v[48:51], v[96:99], v[152:167]
    ds_read_b64_tr_b16 v[40:41], v13 offset:36928
    ds_read_b64_tr_b16 v[42:43], v13 offset:37696
    s_add_u32 s48, s48, 88064
    s_cmp_ge_u32 s48, s49
    s_cselect_b32 s38, 1409024, 0
    s_sub_u32 s48, s48, s38
    s_add_u32 m0, s43, 57344
    s_nop 0
    buffer_load_dwordx4 v17, s[52:55], s48 offen offset:0 lds
    v_mfma_f32_32x32x16_bf16 v[168:183], v[48:51], v[100:103], v[168:183]
    ds_read_b128 v[56:59], v9 offset:0
    ds_read_b128 v[60:63], v9 offset:4096
    v_mfma_f32_32x32x16_bf16 v[184:199], v[52:55], v[96:99], v[184:199]
    ds_read_b128 v[64:67], v10 offset:0
    v_mfma_f32_32x32x16_bf16 v[200:215], v[52:55], v[100:103], v[200:215]
    ds_read_b128 v[68:71], v10 offset:4096
    buffer_load_dwordx4 v18, s[52:55], s48 offen offset:1024 lds
    s_waitcnt lgkmcnt(8)
    v_mfma_f32_32x32x16_bf16 v[120:135], v[32:35], v[104:107], v[120:135]
    ds_read_b64_tr_b16 v[44:45], v15 offset:36864
    ds_read_b64_tr_b16 v[46:47], v15 offset:37632
    v_mfma_f32_32x32x16_bf16 v[136:151], v[32:35], v[108:111], v[136:151]
    ds_read_b64_tr_b16 v[48:49], v16 offset:36864
    ds_read_b64_tr_b16 v[50:51], v16 offset:37632
    v_mfma_f32_16x16x32_bf16 v[216:219], v[24:27], v[32:35], v[216:219]
    s_waitcnt lgkmcnt(10)
    v_mfma_f32_32x32x16_bf16 v[152:167], v[36:39], v[104:107], v[152:167]
    ds_read_b64_tr_b16 v[52:53], v15 offset:36928
    ds_read_b64_tr_b16 v[54:55], v15 offset:37696
    v_mfma_f32_32x32x16_bf16 v[168:183], v[36:39], v[108:111], v[168:183]
    ds_read_b128 v[72:75], v11 offset:0
    ds_read_b128 v[76:79], v11 offset:4096
    v_mfma_f32_16x16x32_bf16 v[220:223], v[24:27], v[36:39], v[220:223]
    s_waitcnt lgkmcnt(12)
    v_mfma_f32_32x32x16_bf16 v[184:199], v[40:43], v[104:107], v[184:199]
    ds_read_b128 v[80:83], v12 offset:0
    v_mfma_f32_32x32x16_bf16 v[200:215], v[40:43], v[108:111], v[200:215]
    ds_read_b128 v[84:87], v12 offset:4096
    v_mfma_f32_16x16x32_bf16 v[224:227], v[24:27], v[40:43], v[224:227]
    buffer_load_dwordx4 v19, s[52:55], s48 offen offset:2048 lds
    v_and_b32 v2, 0x1f0, v8
    buffer_load_dwordx4 v[4:7], v8, s[12:15], s46 offen sc0 sc1
    buffer_load_dwordx4 v[28:31], v2, s[12:15], s47 offen sc0 sc1
    s_waitcnt vmcnt(16)
    s_waitcnt lgkmcnt(0)
    s_barrier
    v_mfma_f32_32x32x16_bf16 v[120:135], v[44:47], v[112:115], v[120:135]
    ds_read_b64_tr_b16 v[32:33], v13 offset:0
    ds_read_b64_tr_b16 v[34:35], v13 offset:768
    v_mfma_f32_32x32x16_bf16 v[136:151], v[44:47], v[116:119], v[136:151]
    ds_read_b64_tr_b16 v[36:37], v14 offset:0
    ds_read_b64_tr_b16 v[38:39], v14 offset:768
    v_mfma_f32_32x32x16_bf16 v[152:167], v[48:51], v[112:115], v[152:167]
    ds_read_b64_tr_b16 v[40:41], v13 offset:64
    ds_read_b64_tr_b16 v[42:43], v13 offset:832
    s_add_u32 s48, s48, 88064
    s_cmp_ge_u32 s48, s49
    s_cselect_b32 s38, 1409024, 0
    s_sub_u32 s48, s48, s38
    s_add_u32 m0, s43, 69632
    s_nop 0
    buffer_load_dwordx4 v17, s[52:55], s48 offen offset:0 lds
    v_mfma_f32_32x32x16_bf16 v[168:183], v[48:51], v[116:119], v[168:183]
    v_mfma_f32_32x32x16_bf16 v[184:199], v[52:55], v[112:115], v[184:199]
    v_mfma_f32_32x32x16_bf16 v[200:215], v[52:55], v[116:119], v[200:215]
    buffer_load_dwordx4 v18, s[52:55], s48 offen offset:1024 lds
    s_waitcnt lgkmcnt(4)
    v_mfma_f32_32x32x16_bf16 v[120:135], v[32:35], v[56:59], v[120:135]
    ds_read_b64_tr_b16 v[44:45], v15 offset:0
    ds_read_b64_tr_b16 v[46:47], v15 offset:768
    v_mfma_f32_32x32x16_bf16 v[136:151], v[32:35], v[60:63], v[136:151]
    ds_read_b64_tr_b16 v[48:49], v16 offset:0
    ds_read_b64_tr_b16 v[50:51], v16 offset:768
    v_mfma_f32_16x16x32_bf16 v[216:219], v[24:27], v[32:35], v[216:219]
    s_waitcnt lgkmcnt(6)
    v_mfma_f32_32x32x16_bf16 v[152:167], v[36:39], v[56:59], v[152:167]
    ds_read_b64_tr_b16 v[52:53], v15 offset:64
    ds_read_b64_tr_b16 v[54:55], v15 offset:832
    v_mfma_f32_32x32x16_bf16 v[168:183], v[36:39], v[60:63], v[168:183]
    v_mfma_f32_16x16x32_bf16 v[220:223], v[24:27], v[36:39], v[220:223]
    s_waitcnt lgkmcnt(6)
    v_mfma_f32_32x32x16_bf16 v[184:199], v[40:43], v[56:59], v[184:199]
    v_mfma_f32_32x32x16_bf16 v[200:215], v[40:43], v[60:63], v[200:215]
    v_mfma_f32_16x16x32_bf16 v[224:227], v[24:27], v[40:43], v[224:227]
    buffer_load_dwordx4 v19, s[52:55], s48 offen offset:2048 lds
    s_waitcnt vmcnt(16)
    s_waitcnt vmcnt(12)
    s_waitcnt lgkmcnt(0)
    s_barrier
    v_mfma_f32_32x32x16_bf16 v[120:135], v[44:47], v[64:67], v[120:135]
    ds_read_b64_tr_b16 v[32:33], v13 offset:12288
    ds_read_b64_tr_b16 v[34:35], v13 offset:13056
    v_mfma_f32_32x32x16_bf16 v[136:151], v[44:47], v[68:71], v[136:151]
    ds_read_b64_tr_b16 v[36:37], v14 offset:12288
    ds_read_b64_tr_b16 v[38:39], v14 offset:13056
    v_mfma_f32_32x32x16_bf16 v[152:167], v[48:51], v[64:67], v[152:167]
    ds_read_b64_tr_b16 v[40:41], v13 offset:12352
    ds_read_b64_tr_b16 v[42:43], v13 offset:13120
    v_mfma_f32_32x32x16_bf16 v[168:183], v[48:51], v[68:71], v[168:183]
    ds_read_b128 v[88:91], v9 offset:16384
    ds_read_b128 v[92:95], v9 offset:20480
    v_mfma_f32_32x32x16_bf16 v[184:199], v[52:55], v[64:67], v[184:199]
    ds_read_b128 v[96:99], v10 offset:16384
    v_mfma_f32_32x32x16_bf16 v[200:215], v[52:55], v[68:71], v[200:215]
    ds_read_b128 v[100:103], v10 offset:20480
    s_mul_i32 s38, s33, 344*128
    v_lshlrev_b32 v2, 7, v0
    buffer_load_dword v228, v2, s[8:11], s38 offen
    v_min_u32 v3, 87, v0
    v_lshlrev_b32 v3, 7, v3
    s_add_u32 s38, s38, 256*128
    buffer_load_dword v229, v3, s[8:11], s38 offen
    s_waitcnt lgkmcnt(8)
    v_mfma_f32_32x32x16_bf16 v[120:135], v[32:35], v[72:75], v[120:135]
    ds_read_b64_tr_b16 v[44:45], v15 offset:12288
    ds_read_b64_tr_b16 v[46:47], v15 offset:13056
    v_mfma_f32_32x32x16_bf16 v[136:151], v[32:35], v[76:79], v[136:151]
    ds_read_b64_tr_b16 v[48:49], v16 offset:12288
    ds_read_b64_tr_b16 v[50:51], v16 offset:13056
    v_mfma_f32_16x16x32_bf16 v[216:219], v[24:27], v[32:35], v[216:219]
    s_waitcnt lgkmcnt(10)
    v_mfma_f32_32x32x16_bf16 v[152:167], v[36:39], v[72:75], v[152:167]
    ds_read_b64_tr_b16 v[52:53], v15 offset:12352
    ds_read_b64_tr_b16 v[54:55], v15 offset:13120
    v_mfma_f32_32x32x16_bf16 v[168:183], v[36:39], v[76:79], v[168:183]
    ds_read_b128 v[104:107], v11 offset:16384
    ds_read_b128 v[108:111], v11 offset:20480
    v_mfma_f32_16x16x32_bf16 v[220:223], v[24:27], v[36:39], v[220:223]
    s_waitcnt lgkmcnt(12)
    v_mfma_f32_32x32x16_bf16 v[184:199], v[40:43], v[72:75], v[184:199]
    ds_read_b128 v[112:115], v12 offset:16384
    v_mfma_f32_32x32x16_bf16 v[200:215], v[40:43], v[76:79], v[200:215]
    ds_read_b128 v[116:119], v12 offset:20480
    v_mfma_f32_16x16x32_bf16 v[224:227], v[24:27], v[40:43], v[224:227]
    s_waitcnt vmcnt(7)
    s_waitcnt lgkmcnt(0)
    s_barrier
    v_mfma_f32_32x32x16_bf16 v[120:135], v[44:47], v[80:83], v[120:135]
    ds_read_b64_tr_b16 v[32:33], v13 offset:24576
    ds_read_b64_tr_b16 v[34:35], v13 offset:25344
    v_mfma_f32_32x32x16_bf16 v[136:151], v[44:47], v[84:87], v[136:151]
    ds_read_b64_tr_b16 v[36:37], v14 offset:24576
    ds_read_b64_tr_b16 v[38:39], v14 offset:25344
    v_mfma_f32_32x32x16_bf16 v[152:167], v[48:51], v[80:83], v[152:167]
    ds_read_b64_tr_b16 v[40:41], v13 offset:24640
    ds_read_b64_tr_b16 v[42:43], v13 offset:25408
    v_mfma_f32_32x32x16_bf16 v[168:183], v[48:51], v[84:87], v[168:183]
    v_mfma_f32_32x32x16_bf16 v[184:199], v[52:55], v[80:83], v[184:199]
    v_mfma_f32_32x32x16_bf16 v[200:215], v[52:55], v[84:87], v[200:215]
    s_waitcnt lgkmcnt(4)
    v_mfma_f32_32x32x16_bf16 v[120:135], v[32:35], v[88:91], v[120:135]
    ds_read_b64_tr_b16 v[44:45], v15 offset:24576
    ds_read_b64_tr_b16 v[46:47], v15 offset:25344
    v_mfma_f32_32x32x16_bf16 v[136:151], v[32:35], v[92:95], v[136:151]
    ds_read_b64_tr_b16 v[48:49], v16 offset:24576
    ds_read_b64_tr_b16 v[50:51], v16 offset:25344
    v_mfma_f32_16x16x32_bf16 v[216:219], v[24:27], v[32:35], v[216:219]
    s_waitcnt lgkmcnt(6)
    v_mfma_f32_32x32x16_bf16 v[152:167], v[36:39], v[88:91], v[152:167]
    ds_read_b64_tr_b16 v[52:53], v15 offset:24640
    ds_read_b64_tr_b16 v[54:55], v15 offset:25408
    v_mfma_f32_32x32x16_bf16 v[168:183], v[36:39], v[92:95], v[168:183]
    v_mfma_f32_16x16x32_bf16 v[220:223], v[24:27], v[36:39], v[220:223]
    s_waitcnt lgkmcnt(6)
    v_mfma_f32_32x32x16_bf16 v[184:199], v[40:43], v[88:91], v[184:199]
    v_mfma_f32_32x32x16_bf16 v[200:215], v[40:43], v[92:95], v[200:215]
    v_mfma_f32_16x16x32_bf16 v[224:227], v[24:27], v[40:43], v[224:227]
    s_waitcnt vmcnt(2)
    s_waitcnt lgkmcnt(0)
    s_barrier
    v_mfma_f32_32x32x16_bf16 v[120:135], v[44:47], v[96:99], v[120:135]
    ds_read_b64_tr_b16 v[32:33], v13 offset:36864
    ds_read_b64_tr_b16 v[34:35], v13 offset:37632
    v_mfma_f32_32x32x16_bf16 v[136:151], v[44:47], v[100:103], v[136:151]
    ds_read_b64_tr_b16 v[36:37], v14 offset:36864
    ds_read_b64_tr_b16 v[38:39], v14 offset:37632
    v_mfma_f32_32x32x16_bf16 v[152:167], v[48:51], v[96:99], v[152:167]
    ds_read_b64_tr_b16 v[40:41], v13 offset:36928
    ds_read_b64_tr_b16 v[42:43], v13 offset:37696
    v_mfma_f32_32x32x16_bf16 v[168:183], v[48:51], v[100:103], v[168:183]
    v_mfma_f32_32x32x16_bf16 v[184:199], v[52:55], v[96:99], v[184:199]
    v_mfma_f32_32x32x16_bf16 v[200:215], v[52:55], v[100:103], v[200:215]
    s_waitcnt lgkmcnt(2)
    v_mfma_f32_32x32x16_bf16 v[120:135], v[32:35], v[104:107], v[120:135]
    ds_read_b64_tr_b16 v[44:45], v15 offset:36864
    ds_read_b64_tr_b16 v[46:47], v15 offset:37632
    s_mov_b32 s92, 200000
gr_l2:
    v_cmp_ne_u64 vcc, s[90:91], v[6:7]
    v_cmp_ne_u64 s[44:45], s[90:91], v[30:31]
    s_nop 0
    s_or_b64 vcc, vcc, s[44:45]
    s_cbranch_scc0 gr_d2
    v_and_b32 v2, 0x1f0, v8
    buffer_load_dwordx4 v[4:7], v8, s[12:15], s46 offen sc0 sc1
    buffer_load_dwordx4 v[28:31], v2, s[12:15], s47 offen sc0 sc1
    s_waitcnt vmcnt(0)
    s_sub_u32 s92, s92, 1
    s_cmp_lg_u32 s92, 0
    s_cbranch_scc1 gr_l2
gr_d2:
    v_mov_b32 v6, v4
    v_mov_b32 v7, v5
    s_nop 1
    v_permlane32_swap_b32 v4, v6
    v_permlane32_swap_b32 v5, v7
    v_mfma_f32_32x32x16_bf16 v[136:151], v[32:35], v[108:111], v[136:151]
    ds_read_b64_tr_b16 v[48:49], v16 offset:36864
    ds_read_b64_tr_b16 v[50:51], v16 offset:37632
    v_mfma_f32_16x16x32_bf16 v[216:219], v[24:27], v[32:35], v[216:219]
    s_waitcnt lgkmcnt(4)
    v_mfma_f32_32x32x16_bf16 v[152:167], v[36:39], v[104:107], v[152:167]
    ds_read_b64_tr_b16 v[52:53], v15 offset:36928
    ds_read_b64_tr_b16 v[54:55], v15 offset:37696
    v_mfma_f32_16x16x32_bf16 v[220:223], v[24:27], v[36:39], v[220:223]
    v_mfma_f32_32x32x16_bf16 v[168:183], v[36:39], v[108:111], v[168:183]
    v_mfma_f32_16x16x32_bf16 v[224:227], v[24:27], v[40:43], v[224:227]
    v_mfma_f32_32x32x16_bf16 v[184:199], v[40:43], v[104:107], v[184:199]
    v_mfma_f32_32x32x16_bf16 v[200:215], v[40:43], v[108:111], v[200:215]
    v_and_b32 v2, 31, v1
    v_lshrrev_b32 v3, 5, v1
    v_lshlrev_b32 v2, 2, v2
    v_lshl_add_u32 v2, v3, 12, v2
    s_lshl_b32 s38, s5, 9
    s_add_u32 s38, s38, s37
    v_xor_b32 v2, s38, v2
    ds_write_b32 v2, v216 offset:0
    ds_write_b32 v2, v220 offset:128
    ds_write_b32 v2, v224 offset:256
    s_waitcnt lgkmcnt(0)
    s_barrier
    s_setprio 3
    v_and_b32 v2, 31, v1
    v_lshrrev_b32 v3, 5, v1
    v_lshlrev_b32 v2, 2, v2
    v_lshl_add_u32 v2, v3, 9, v2
    v_add_u32 v2, s37, v2
    ds_read_b32 v216, v2 offset:0
    ds_read_b32 v217, v2 offset:128
    ds_read_b32 v218, v2 offset:256
    v_mfma_f32_32x32x16_bf16 v[120:135], v[44:47], v[112:115], v[120:135]
    v_mov_b32 v56, 0
    v_mov_b32 v57, 0
    v_mov_b32 v60, 0
    v_mov_b32 v61, 0
    v_mov_b32 v64, 0
    v_mov_b32 v65, 0
    v_cvt_pk_bf16_f32 v58, v4, v4
    s_add_u32 s38, s41, 327680
    s_add_u32 m0, s37, 8192
    s_nop 0
    buffer_load_dwordx4 v22, s[8:11], s38 offen lds
    s_add_u32 s38, s41, 335872
    s_add_u32 m0, s37, 9216
    s_nop 0
    buffer_load_dwordx4 v22, s[8:11], s38 offen lds
    v_mfma_f32_32x32x16_bf16 v[136:151], v[44:47], v[116:119], v[136:151]
    v_cvt_pk_bf16_f32 v59, v4, v4
    v_cvt_pk_bf16_f32 v62, v6, v6
    v_cvt_pk_bf16_f32 v63, v6, v6
    v_mov_b32 v74, 0
    v_mov_b32 v75, 0
    s_add_u32 s43, s42, 88064
    s_waitcnt lgkmcnt(2)
    s_add_u32 s38, s41, 311296
    s_add_u32 m0, s37, 16384
    s_nop 0
    buffer_load_dwordx4 v22, s[8:11], s38 offen lds
    s_add_u32 s38, s41, 319488
    s_add_u32 m0, s37, 17408
    s_nop 0
    buffer_load_dwordx4 v22, s[8:11], s38 offen lds
    v_mfma_f32_32x32x16_bf16 v[152:167], v[48:51], v[112:115], v[152:167]
    v_and_b32 v76, s40, v216
    v_sub_f32 v216, v216, v76
    v_and_b32 v77, s40, v216
    v_sub_f32 v216, v216, v77
    v_cvt_pk_bf16_f32 v68, v76, v77
    v_cvt_pk_bf16_f32 v69, v216, 0
    s_waitcnt lgkmcnt(1)
    s_add_u32 s38, s41, 294912
    s_add_u32 m0, s37, 24576
    s_nop 0
    buffer_load_dwordx4 v22, s[8:11], s38 offen lds
    s_add_u32 s38, s41, 303104
    s_add_u32 m0, s37, 25600
    s_nop 0
    buffer_load_dwordx4 v22, s[8:11], s38 offen lds
    v_mfma_f32_32x32x16_bf16 v[168:183], v[48:51], v[116:119], v[168:183]
    v_and_b32 v76, s40, v217
    v_sub_f32 v217, v217, v76
    v_and_b32 v77, s40, v217
    v_sub_f32 v217, v217, v77
    v_cvt_pk_bf16_f32 v70, v76, v77
    v_cvt_pk_bf16_f32 v71, v217, 0
    s_waitcnt lgkmcnt(0)
    s_add_u32 s38, s41, 278528
    s_add_u32 m0, s37, 32768
    s_nop 0
    buffer_load_dwordx4 v22, s[8:11], s38 offen lds
    s_add_u32 s38, s41, 286720
    s_add_u32 m0, s37, 33792
    s_nop 0
    buffer_load_dwordx4 v22, s[8:11], s38 offen lds
    v_mfma_f32_32x32x16_bf16 v[184:199], v[52:55], v[112:115], v[184:199]
    v_and_b32 v76, s40, v218
    v_sub_f32 v218, v218, v76
    v_and_b32 v77, s40, v218
    v_sub_f32 v218, v218, v77
    v_cvt_pk_bf16_f32 v72, v76, v77
    v_cvt_pk_bf16_f32 v73, v218, 0
    s_add_u32 s38, s41, 262144
    s_add_u32 m0, s37, 40960
    s_nop 0
    buffer_load_dwordx4 v22, s[8:11], s38 offen lds
    s_add_u32 s38, s41, 270336
    s_add_u32 m0, s37, 41984
    s_nop 0
    buffer_load_dwordx4 v22, s[8:11], s38 offen lds
    v_mfma_f32_32x32x16_bf16 v[200:215], v[52:55], v[116:119], v[200:215]
    s_add_u32 s38, s41, 245760
    s_add_u32 m0, s37, 49152
    s_nop 0
    buffer_load_dwordx4 v22, s[8:11], s38 offen lds
    s_add_u32 s38, s41, 253952
    s_add_u32 m0, s37, 50176
    s_nop 0
    buffer_load_dwordx4 v22, s[8:11], s38 offen lds
    s_nop 1
    v_mfma_f32_32x32x16_bf16 v[120:135], v[68:71], v[58:61], v[120:135]
    v_mfma_f32_32x32x16_bf16 v[136:151], v[68:71], v[62:65], v[136:151]
    v_mfma_f32_32x32x16_bf16 v[152:167], v[68:71], v[56:59], v[152:167]
    v_mul_f32 v120, v120, v5
    v_mul_f32 v121, v121, v5
    v_mul_f32 v122, v122, v5
    v_mul_f32 v123, v123, v5
    v_mul_f32 v124, v124, v5
    v_mul_f32 v125, v125, v5
    v_mul_f32 v126, v126, v5
    v_mfma_f32_32x32x16_bf16 v[168:183], v[68:71], v[60:63], v[168:183]
    v_mul_f32 v127, v127, v5
    v_mul_f32 v128, v128, v5
    v_mul_f32 v129, v129, v5
    v_mul_f32 v130, v130, v5
    v_mul_f32 v131, v131, v5
    v_mul_f32 v132, v132, v5
    v_mul_f32 v133, v133, v5
    v_mfma_f32_32x32x16_bf16 v[184:199], v[72:75], v[58:61], v[184:199]
    v_mul_f32 v134, v134, v5
    v_mul_f32 v135, v135, v5
    v_cvt_pk_bf16_f32 v120, 0, v120
    v_cvt_pk_bf16_f32 v121, 0, v121
    v_cvt_pk_bf16_f32 v122, 0, v122
    v_cvt_pk_bf16_f32 v123, 0, v123
    v_cvt_pk_bf16_f32 v124, 0, v124
    v_mfma_f32_32x32x16_bf16 v[200:215], v[72:75], v[62:65], v[200:215]
    v_cvt_pk_bf16_f32 v125, 0, v125
    v_cvt_pk_bf16_f32 v126, 0, v126
    v_cvt_pk_bf16_f32 v127, 0, v127
    v_cvt_pk_bf16_f32 v128, 0, v128
    v_cvt_pk_bf16_f32 v129, 0, v129
    v_cvt_pk_bf16_f32 v130, 0, v130
    v_cvt_pk_bf16_f32 v131, 0, v131
    v_cvt_pk_bf16_f32 v132, 0, v132
    v_cvt_pk_bf16_f32 v133, 0, v133
    v_cvt_pk_bf16_f32 v134, 0, v134
    v_cvt_pk_bf16_f32 v135, 0, v135
    v_mul_f32 v120, v120, v128
    v_mul_f32 v121, v121, v129
    v_mul_f32 v122, v122, v130
    v_mul_f32 v123, v123, v131
    v_mul_f32 v124, v124, v132
    v_mul_f32 v125, v125, v133
    v_mul_f32 v126, v126, v134
    v_mul_f32 v127, v127, v135
    v_cvt_pk_bf16_f32 v128, v120, v121
    v_cvt_pk_bf16_f32 v129, v122, v123
    v_cvt_pk_bf16_f32 v130, v124, v125
    v_cvt_pk_bf16_f32 v131, v126, v127
    s_nop 1
    v_permlane32_swap_b32 v128, v130
    v_permlane32_swap_b32 v129, v131
    buffer_store_dwordx4 v[128:131], v8, s[24:27], s42 offen offset:0 sc0 sc1
    v_mul_f32 v136, v136, v7
    v_mul_f32 v137, v137, v7
    v_mul_f32 v138, v138, v7
    v_mul_f32 v139, v139, v7
    v_mul_f32 v140, v140, v7
    v_mul_f32 v141, v141, v7
    v_mul_f32 v142, v142, v7
    v_mul_f32 v143, v143, v7
    v_mul_f32 v144, v144, v7
    v_mul_f32 v145, v145, v7
    v_mul_f32 v146, v146, v7
    v_mul_f32 v147, v147, v7
    v_mul_f32 v148, v148, v7
    v_mul_f32 v149, v149, v7
    v_mul_f32 v150, v150, v7
    v_mul_f32 v151, v151, v7
    v_cvt_pk_bf16_f32 v136, 0, v136
    v_cvt_pk_bf16_f32 v137, 0, v137
    v_cvt_pk_bf16_f32 v138, 0, v138
    v_cvt_pk_bf16_f32 v139, 0, v139
    v_cvt_pk_bf16_f32 v140, 0, v140
    v_cvt_pk_bf16_f32 v141, 0, v141
    v_cvt_pk_bf16_f32 v142, 0, v142
    v_cvt_pk_bf16_f32 v143, 0, v143
    v_cvt_pk_bf16_f32 v144, 0, v144
    v_cvt_pk_bf16_f32 v145, 0, v145
    v_cvt_pk_bf16_f32 v146, 0, v146
    v_cvt_pk_bf16_f32 v147, 0, v147
    v_cvt_pk_bf16_f32 v148, 0, v148
    v_cvt_pk_bf16_f32 v149, 0, v149
    v_cvt_pk_bf16_f32 v150, 0, v150
    v_cvt_pk_bf16_f32 v151, 0, v151
    v_mul_f32 v136, v136, v144
    v_mul_f32 v137, v137, v145
    v_mul_f32 v138, v138, v146
    v_mul_f32 v139, v139, v147
    v_mul_f32 v140, v140, v148
    v_mul_f32 v141, v141, v149
    v_mul_f32 v142, v142, v150
    v_mul_f32 v143, v143, v151
    v_cvt_pk_bf16_f32 v144, v136, v137
    v_cvt_pk_bf16_f32 v145, v138, v139
    v_cvt_pk_bf16_f32 v146, v140, v141
    v_cvt_pk_bf16_f32 v147, v142, v143
    s_nop 1
    v_permlane32_swap_b32 v144, v146
    v_permlane32_swap_b32 v145, v147
    buffer_store_dwordx4 v[144:147], v8, s[24:27], s43 offen offset:0 sc0 sc1
    v_mul_f32 v152, v152, v5
    v_mul_f32 v153, v153, v5
    v_mul_f32 v154, v154, v5
    v_mul_f32 v155, v155, v5
    v_mul_f32 v156, v156, v5
    v_mul_f32 v157, v157, v5
    v_mul_f32 v158, v158, v5
    v_mul_f32 v159, v159, v5
    v_mul_f32 v160, v160, v5
    v_mul_f32 v161, v161, v5
    v_mul_f32 v162, v162, v5
    v_mul_f32 v163, v163, v5
    v_mul_f32 v164, v164, v5
    v_mul_f32 v165, v165, v5
    v_mul_f32 v166, v166, v5
    v_mul_f32 v167, v167, v5
    v_cvt_pk_bf16_f32 v152, 0, v152
    v_cvt_pk_bf16_f32 v153, 0, v153
    v_cvt_pk_bf16_f32 v154, 0, v154
    v_cvt_pk_bf16_f32 v155, 0, v155
    v_cvt_pk_bf16_f32 v156, 0, v156
    v_cvt_pk_bf16_f32 v157, 0, v157
    v_cvt_pk_bf16_f32 v158, 0, v158
    v_cvt_pk_bf16_f32 v159, 0, v159
    v_cvt_pk_bf16_f32 v160, 0, v160
    v_cvt_pk_bf16_f32 v161, 0, v161
    v_cvt_pk_bf16_f32 v162, 0, v162
    v_cvt_pk_bf16_f32 v163, 0, v163
    v_cvt_pk_bf16_f32 v164, 0, v164
    v_cvt_pk_bf16_f32 v165, 0, v165
    v_cvt_pk_bf16_f32 v166, 0, v166
    v_cvt_pk_bf16_f32 v167, 0, v167
    v_mul_f32 v152, v152, v160
    v_mul_f32 v153, v153, v161
    v_mul_f32 v154, v154, v162
    v_mul_f32 v155, v155, v163
    v_mul_f32 v156, v156, v164
    v_mul_f32 v157, v157, v165
    v_mul_f32 v158, v158, v166
    v_mul_f32 v159, v159, v167
    v_cvt_pk_bf16_f32 v160, v152, v153
    v_cvt_pk_bf16_f32 v161, v154, v155
    v_cvt_pk_bf16_f32 v162, v156, v157
    v_cvt_pk_bf16_f32 v163, v158, v159
    s_nop 1
    v_permlane32_swap_b32 v160, v162
    v_permlane32_swap_b32 v161, v163
    buffer_store_dwordx4 v[160:163], v8, s[24:27], s42 offen offset:1024 sc0 sc1
    v_mul_f32 v168, v168, v7
    v_mul_f32 v169, v169, v7
    v_mul_f32 v170, v170, v7
    v_mul_f32 v171, v171, v7
    v_mul_f32 v172, v172, v7
    v_mul_f32 v173, v173, v7
    v_mul_f32 v174, v174, v7
    v_mul_f32 v175, v175, v7
    v_mul_f32 v176, v176, v7
    v_mul_f32 v177, v177, v7
    v_mul_f32 v178, v178, v7
    v_mul_f32 v179, v179, v7
    v_mul_f32 v180, v180, v7
    v_mul_f32 v181, v181, v7
    v_mul_f32 v182, v182, v7
    v_mul_f32 v183, v183, v7
    v_cvt_pk_bf16_f32 v168, 0, v168
    v_cvt_pk_bf16_f32 v169, 0, v169
    v_cvt_pk_bf16_f32 v170, 0, v170
    v_cvt_pk_bf16_f32 v171, 0, v171
    v_cvt_pk_bf16_f32 v172, 0, v172
    v_cvt_pk_bf16_f32 v173, 0, v173
    v_cvt_pk_bf16_f32 v174, 0, v174
    v_cvt_pk_bf16_f32 v175, 0, v175
    v_cvt_pk_bf16_f32 v176, 0, v176
    v_cvt_pk_bf16_f32 v177, 0, v177
    v_cvt_pk_bf16_f32 v178, 0, v178
    v_cvt_pk_bf16_f32 v179, 0, v179
    v_cvt_pk_bf16_f32 v180, 0, v180
    v_cvt_pk_bf16_f32 v181, 0, v181
    v_cvt_pk_bf16_f32 v182, 0, v182
    v_cvt_pk_bf16_f32 v183, 0, v183
    v_mul_f32 v168, v168, v176
    v_mul_f32 v169, v169, v177
    v_mul_f32 v170, v170, v178
    v_mul_f32 v171, v171, v179
    v_mul_f32 v172, v172, v180
    v_mul_f32 v173, v173, v181
    v_mul_f32 v174, v174, v182
    v_mul_f32 v175, v175, v183
    v_cvt_pk_bf16_f32 v176, v168, v169
    v_cvt_pk_bf16_f32 v177, v170, v171
    v_cvt_pk_bf16_f32 v178, v172, v173
    v_cvt_pk_bf16_f32 v179, v174, v175
    s_nop 1
    v_permlane32_swap_b32 v176, v178
    v_permlane32_swap_b32 v177, v179
    buffer_store_dwordx4 v[176:179], v8, s[24:27], s43 offen offset:1024 sc0 sc1
    v_mul_f32 v184, v184, v5
    v_mul_f32 v185, v185, v5
    v_mul_f32 v186, v186, v5
    v_mul_f32 v187, v187, v5
    v_mul_f32 v188, v188, v5
    v_mul_f32 v189, v189, v5
    v_mul_f32 v190, v190, v5
    v_mul_f32 v191, v191, v5
    v_mul_f32 v192, v192, v5
    v_mul_f32 v193, v193, v5
    v_mul_f32 v194, v194, v5
    v_mul_f32 v195, v195, v5
    v_mul_f32 v196, v196, v5
    v_mul_f32 v197, v197, v5
    v_mul_f32 v198, v198, v5
    v_mul_f32 v199, v199, v5
    v_cvt_pk_bf16_f32 v184, 0, v184
    v_cvt_pk_bf16_f32 v185, 0, v185
    v_cvt_pk_bf16_f32 v186, 0, v186
    v_cvt_pk_bf16_f32 v187, 0, v187
    v_cvt_pk_bf16_f32 v188, 0, v188
    v_cvt_pk_bf16_f32 v189, 0, v189
    v_cvt_pk_bf16_f32 v190, 0, v190
    v_cvt_pk_bf16_f32 v191, 0, v191
    v_cvt_pk_bf16_f32 v192, 0, v192
    v_cvt_pk_bf16_f32 v193, 0, v193
    v_cvt_pk_bf16_f32 v194, 0, v194
    v_cvt_pk_bf16_f32 v195, 0, v195
    v_cvt_pk_bf16_f32 v196, 0, v196
    v_cvt_pk_bf16_f32 v197, 0, v197
    v_cvt_pk_bf16_f32 v198, 0, v198
    v_cvt_pk_bf16_f32 v199, 0, v199
    v_mul_f32 v184, v184, v192
    v_mul_f32 v185, v185, v193
    v_mul_f32 v186, v186, v194
    v_mul_f32 v187, v187, v195
    v_mul_f32 v188, v188, v196
    v_mul_f32 v189, v189, v197
    v_mul_f32 v190, v190, v198
    v_mul_f32 v191, v191, v199
    v_cvt_pk_bf16_f32 v192, v184, v185
    v_cvt_pk_bf16_f32 v193, v186, v187
    v_cvt_pk_bf16_f32 v194, v188, v189
    v_cvt_pk_bf16_f32 v195, v190, v191
    s_nop 1
    v_permlane32_swap_b32 v192, v194
    v_permlane32_swap_b32 v193, v195
    buffer_store_dwordx4 v[192:195], v8, s[24:27], s42 offen offset:2048 sc0 sc1
    v_mul_f32 v200, v200, v7
    v_mul_f32 v201, v201, v7
    v_mul_f32 v202, v202, v7
    v_mul_f32 v203, v203, v7
    v_mul_f32 v204, v204, v7
    v_mul_f32 v205, v205, v7
    v_mul_f32 v206, v206, v7
    v_mul_f32 v207, v207, v7
    v_mul_f32 v208, v208, v7
    v_mul_f32 v209, v209, v7
    v_mul_f32 v210, v210, v7
    v_mul_f32 v211, v211, v7
    v_mul_f32 v212, v212, v7
    v_mul_f32 v213, v213, v7
    v_mul_f32 v214, v214, v7
    v_mul_f32 v215, v215, v7
    v_cvt_pk_bf16_f32 v200, 0, v200
    v_cvt_pk_bf16_f32 v201, 0, v201
    v_cvt_pk_bf16_f32 v202, 0, v202
    v_cvt_pk_bf16_f32 v203, 0, v203
    v_cvt_pk_bf16_f32 v204, 0, v204
    v_cvt_pk_bf16_f32 v205, 0, v205
    v_cvt_pk_bf16_f32 v206, 0, v206
    v_cvt_pk_bf16_f32 v207, 0, v207
    v_cvt_pk_bf16_f32 v208, 0, v208
    v_cvt_pk_bf16_f32 v209, 0, v209
    v_cvt_pk_bf16_f32 v210, 0, v210
    v_cvt_pk_bf16_f32 v211, 0, v211
    v_cvt_pk_bf16_f32 v212, 0, v212
    v_cvt_pk_bf16_f32 v213, 0, v213
    v_cvt_pk_bf16_f32 v214, 0, v214
    v_cvt_pk_bf16_f32 v215, 0, v215
    v_mul_f32 v200, v200, v208
    v_mul_f32 v201, v201, v209
    v_mul_f32 v202, v202, v210
    v_mul_f32 v203, v203, v211
    v_mul_f32 v204, v204, v212
    v_mul_f32 v205, v205, v213
    v_mul_f32 v206, v206, v214
    v_mul_f32 v207, v207, v215
    v_cvt_pk_bf16_f32 v208, v200, v201
    v_cvt_pk_bf16_f32 v209, v202, v203
    v_cvt_pk_bf16_f32 v210, v204, v205
    v_cvt_pk_bf16_f32 v211, v206, v207
    s_nop 1
    v_permlane32_swap_b32 v208, v210
    v_permlane32_swap_b32 v209, v211
    buffer_store_dwordx4 v[208:211], v8, s[24:27], s43 offen offset:2048 sc0 sc1
    s_branch phase_c
g_path2:
    s_add_u32 m0, s7, 0
    s_nop 0
    buffer_load_dwordx4 v20, s[16:19], s32 offen offset:0 lds
    s_add_u32 s38, s32, 7168
    buffer_load_dwordx4 v21, s[16:19], s38 offen offset:1024 lds
    s_add_u32 s38, s32, 14336
    buffer_load_dwordx4 v20, s[16:19], s38 offen offset:2048 lds
    s_add_u32 s38, s32, 21504
    buffer_load_dwordx4 v21, s[16:19], s38 offen offset:3072 lds
    s_mul_i32 s43, s3, 2048
    s_lshr_b32 s5, s3, 1
    s_cmp_eq_u32 s5, 1
    s_cselect_b32 s52, s80, s78
    s_cselect_b32 s53, s81, s79
    s_and_b32 s53, s53, 0xffff
    s_mov_b32 s54, 1409024
    s_mov_b32 s55, 0x00020000
    s_and_b32 s49, s3, 1
    s_mul_i32 s38, s49, 2048
    s_add_u32 s42, s42, s38
    s_mul_i32 s48, s49, 16*2752
    s_add_u32 s48, s48, s36
    s_movk_i32 s49, 2752
    s_lshl_b32 s34, s5, 1
    v_add_u32 v14, 0, v1
    v_lshrrev_b32 v15, 3, v14
    v_and_b32 v14, 7, v14
    v_bfe_u32 v13, v1, 4, 1
    v_lshlrev_b32 v13, 2, v13
    v_xor_b32 v14, v14, v13
    v_xor_b32 v14, s34, v14
    v_mul_lo_u32 v15, v15, s49
    v_lshl_add_u32 v17, v14, 4, v15
    v_add_u32 v14, 64, v1
    v_lshrrev_b32 v15, 3, v14
    v_and_b32 v14, 7, v14
    v_bfe_u32 v13, v1, 4, 1
    v_lshlrev_b32 v13, 2, v13
    v_xor_b32 v14, v14, v13
    v_xor_b32 v14, s34, v14
    v_mul_lo_u32 v15, v15, s49
    v_lshl_add_u32 v18, v14, 4, v15
    v_subrev_u32 v18, 1024, v18
    s_add_u32 s49, s48, 1409024
    s_mul_i32 s38, s29, 88064
    s_add_u32 s48, s48, s38
    s_add_u32 m0, s43, 32768
    s_nop 0
    buffer_load_dwordx4 v17, s[52:55], s48 offen offset:0 lds
    buffer_load_dwordx4 v18, s[52:55], s48 offen offset:1024 lds
    s_add_u32 s48, s48, 88064
    s_cmp_ge_u32 s48, s49
    s_cselect_b32 s38, 1409024, 0
    s_sub_u32 s48, s48, s38
    s_add_u32 m0, s43, 40960
    s_nop 0
    buffer_load_dwordx4 v17, s[52:55], s48 offen offset:0 lds
    buffer_load_dwordx4 v18, s[52:55], s48 offen offset:1024 lds
    s_add_u32 s32, s32, 128
    s_bitset0_b32 s32, 10
    s_add_u32 m0, s7, 16384
    s_nop 0
    buffer_load_dwordx4 v20, s[16:19], s32 offen offset:0 lds
    s_add_u32 s38, s32, 7168
    buffer_load_dwordx4 v21, s[16:19], s38 offen offset:1024 lds
    s_add_u32 s38, s32, 14336
    buffer_load_dwordx4 v20, s[16:19], s38 offen offset:2048 lds
    s_add_u32 s38, s32, 21504
    buffer_load_dwordx4 v21, s[16:19], s38 offen offset:3072 lds
    s_add_u32 s48, s48, 88064
    s_cmp_ge_u32 s48, s49
    s_cselect_b32 s38, 1409024, 0
    s_sub_u32 s48, s48, s38
    s_add_u32 m0, s43, 49152
    s_nop 0
    buffer_load_dwordx4 v17, s[52:55], s48 offen offset:0 lds
    buffer_load_dwordx4 v18, s[52:55], s48 offen offset:1024 lds
    s_add_u32 s48, s48, 88064
    s_cmp_ge_u32 s48, s49
    s_cselect_b32 s38, 1409024, 0
    s_sub_u32 s48, s48, s38
    s_add_u32 m0, s43, 57344
    s_nop 0
    buffer_load_dwordx4 v17, s[52:55], s48 offen offset:0 lds
    buffer_load_dwordx4 v18, s[52:55], s48 offen offset:1024 lds
    s_add_u32 s48, s48, 88064
    s_cmp_ge_u32 s48, s49
    s_cselect_b32 s38, 1409024, 0
    s_sub_u32 s48, s48, s38
    s_add_u32 m0, s43, 65536
    s_nop 0
    buffer_load_dwordx4 v17, s[52:55], s48 offen offset:0 lds
    buffer_load_dwordx4 v18, s[52:55], s48 offen offset:1024 lds
    s_add_u32 s48, s48, 88064
    s_cmp_ge_u32 s48, s49
    s_cselect_b32 s38, 1409024, 0
    s_sub_u32 s48, s48, s38
    s_add_u32 m0, s43, 73728
    s_nop 0
    buffer_load_dwordx4 v17, s[52:55], s48 offen offset:0 lds
    buffer_load_dwordx4 v18, s[52:55], s48 offen offset:1024 lds
    v_lshrrev_b32 v3, 5, v1
    v_and_b32 v2, 15, v1
    v_lshrrev_b32 v4, 2, v2
    v_lshl_add_u32 v4, v3, 3, v4
    v_mul_u32_u24 v4, 128, v4
    v_bfe_u32 v5, v1, 4, 1
    v_mul_u32_u24 v6, 4096, v5
    v_add_u32 v4, v4, v6
    v_and_b32 v2, 3, v2
    v_lshl_add_u32 v4, v2, 3, v4
    v_lshlrev_b32 v5, 5, v5
    v_bfe_u32 v2, v1, 3, 1
    v_lshlrev_b32 v2, 6, v2
    v_xor_b32 v5, v5, v2
    s_and_b32 s34, s3, 1
    s_mul_i32 s34, s34, 64
    s_mul_i32 s38, s5, 2048
    s_add_u32 s38, s38, 32768
    v_add_u32 v4, s38, v4
    s_add_u32 s38, s34, 0
    v_xor_b32 v6, s38, v5
    v_add_u32 v13, v4, v6
    s_add_u32 s38, s34, 32
    v_xor_b32 v6, s38, v5
    v_add_u32 v14, v4, v6
    s_mul_i32 s38, s5, 4096
    s_sub_u32 s38, 2048, s38
    v_add_u32 v15, s38, v13
    v_add_u32 v16, s38, v14
    v_and_b32 v4, 31, v1
    v_bfe_u32 v5, v1, 1, 3
    v_xor_b32 v5, v5, v3
    v_lshlrev_b32 v5, 4, v5
    v_lshl_add_u32 v5, v4, 7, v5
    s_lshl_b32 s38, s5, 5
    v_xor_b32 v5, s38, v5
    s_lshl_b32 s38, s5, 13
    v_add_u32 v9, s38, v5
    v_xor_b32 v10, 32, v9
    v_xor_b32 v11, 64, v9
    v_xor_b32 v12, 96, v9
    v_lshrrev_b32 v2, 2, v1
    v_lshrrev_b32 v3, 4, v1
    v_xor_b32 v2, v2, v3
    v_and_b32 v2, 1, v2
    v_cmp_eq_u32 vcc, 0, v2
    v_mov_b32 v3, s6
    s_nop 0
    v_cndmask_b32 v24, 0, v3, vcc
    v_cndmask_b32 v25, 0, v3, vcc
    v_cndmask_b32 v26, 0, v3, vcc
    v_cndmask_b32 v27, 0, v3, vcc
    v_and_b32 v2, 31, v1
    v_lshrrev_b32 v3, 5, v1
    v_lshlrev_b32 v23, 10, v2
    v_lshl_add_u32 v23, v3, 3, v23
    s_lshl_b32 s38, s4, 1
    s_and_b32 s34, s3, 1
    s_add_u32 s38, s38, s34
    s_lshl_b32 s38, s38, 15
    s_and_b32 s34, s33, 7
    s_lshl_b32 s34, s34, 7
    s_add_u32 s38, s38, s34
    s_lshl_b32 s34, s5, 6
    s_add_u32 s38, s38, s34
    v_add_u32 v23, s38, v23
    v_mov_b32 v240, 0
    v_mov_b32 v241, 0
    v_mov_b32 v242, 0
    v_mov_b32 v243, 0
    s_waitcnt vmcnt(20)
    v_dot2c_f32_bf16 v240, s6, v120
    v_dot2c_f32_bf16 v242, v120, v120
    v_dot2c_f32_bf16 v241, s6, v121
    v_dot2c_f32_bf16 v243, v121, v121
    v_dot2c_f32_bf16 v240, s6, v122
    v_dot2c_f32_bf16 v242, v122, v122
    v_dot2c_f32_bf16 v241, s6, v123
    v_dot2c_f32_bf16 v243, v123, v123
    v_dot2c_f32_bf16 v240, s6, v124
    v_dot2c_f32_bf16 v242, v124, v124
    v_dot2c_f32_bf16 v241, s6, v125
    v_dot2c_f32_bf16 v243, v125, v125
    v_dot2c_f32_bf16 v240, s6, v126
    v_dot2c_f32_bf16 v242, v126, v126
    v_dot2c_f32_bf16 v241, s6, v127
    v_dot2c_f32_bf16 v243, v127, v127
    s_nop 3
    v_add_f32 v244, v240, v241
    v_add_f32 v245, v242, v243
    s_nop 1
    v_add_f32_dpp v246, v244, v244 quad_perm:[1,0,3,2] row_mask:0xf bank_mask:0xf
    v_add_f32_dpp v247, v245, v245 quad_perm:[1,0,3,2] row_mask:0xf bank_mask:0xf
    s_nop 1
    v_add_f32_dpp v244, v246, v246 quad_perm:[2,3,0,1] row_mask:0xf bank_mask:0xf
    v_add_f32_dpp v245, v247, v247 quad_perm:[2,3,0,1] row_mask:0xf bank_mask:0xf
    s_nop 1
    v_add_f32_dpp v246, v244, v244 row_half_mirror row_mask:0xf bank_mask:0xf
    v_add_f32_dpp v247, v245, v245 row_half_mirror row_mask:0xf bank_mask:0xf
    s_nop 1
    v_add_f32_dpp v244, v246, v246 row_mirror row_mask:0xf bank_mask:0xf
    v_add_f32_dpp v245, v247, v247 row_mirror row_mask:0xf bank_mask:0xf
    v_mov_b32 v246, v244
    v_mov_b32 v247, v245
    s_nop 1
    v_permlane16_swap_b32 v244, v246
    v_permlane16_swap_b32 v245, v247
    s_nop 1
    v_add_f32 v244, v244, v246
    v_add_f32 v245, v245, v247
    v_mul_f32 v244, 0x3b000000, v244
    v_mul_f32 v245, 0x3b000000, v245
    v_fma_f32 v245, -v244, v244, v245
    v_max_f32 v245, 0, v245
    v_cvt_pk_bf16_f32 v244, 0, v244
    v_cvt_pk_bf16_f32 v245, 0, v245
    v_add_f32 v245, 0x3727c5ac, v245
    v_cvt_pk_bf16_f32 v245, 0, v245
    v_sqrt_f32 v245, v245
    v_sub_f32 v228, 0, v244
    v_cvt_pk_bf16_f32 v245, 0, v245
    v_rcp_f32 v229, v245
    buffer_load_dwordx2 v[252:253], off, s[60:63], 0
    s_waitcnt vmcnt(15)
    s_barrier
    ds_read_b128 v[56:59], v9 offset:0
    ds_read_b128 v[60:63], v9 offset:4096
    ds_read_b64_tr_b16 v[32:33], v13 offset:0
    ds_read_b64_tr_b16 v[34:35], v13 offset:512
    ds_read_b64_tr_b16 v[36:37], v14 offset:0
    ds_read_b64_tr_b16 v[38:39], v14 offset:512
    ds_read_b128 v[64:67], v10 offset:0
    ds_read_b128 v[68:71], v10 offset:4096
    ds_read_b128 v[72:75], v11 offset:0
    ds_read_b128 v[76:79], v11 offset:4096
    ds_read_b128 v[80:83], v12 offset:0
    ds_read_b128 v[84:87], v12 offset:4096
    s_waitcnt lgkmcnt(8)
    v_mfma_f32_32x32x16_bf16 v[120:135], v[32:35], v[56:59], 0
    ds_read_b64_tr_b16 v[44:45], v15 offset:0
    ds_read_b64_tr_b16 v[46:47], v15 offset:512
    v_mfma_f32_32x32x16_bf16 v[136:151], v[32:35], v[60:63], 0
    ds_read_b64_tr_b16 v[48:49], v16 offset:0
    ds_read_b64_tr_b16 v[50:51], v16 offset:512
    v_mfma_f32_16x16x32_bf16 v[216:219], v[24:27], v[32:35], 0
    s_waitcnt lgkmcnt(10)
    v_mfma_f32_32x32x16_bf16 v[152:167], v[36:39], v[56:59], 0
    v_mfma_f32_32x32x16_bf16 v[168:183], v[36:39], v[60:63], 0
    v_mfma_f32_16x16x32_bf16 v[220:223], v[24:27], v[36:39], 0
    s_waitcnt vmcnt(13)
    s_waitcnt vmcnt(9)
    s_waitcnt lgkmcnt(0)
    s_barrier
    v_mfma_f32_32x32x16_bf16 v[120:135], v[44:47], v[64:67], v[120:135]
    ds_read_b64_tr_b16 v[32:33], v13 offset:8192
    ds_read_b64_tr_b16 v[34:35], v13 offset:8704
    v_mfma_f32_32x32x16_bf16 v[136:151], v[44:47], v[68:71], v[136:151]
    ds_read_b64_tr_b16 v[36:37], v14 offset:8192
    ds_read_b64_tr_b16 v[38:39], v14 offset:8704
    s_add_u32 s32, s32, 128
    s_bitset0_b32 s32, 10
    s_add_u32 m0, s7, 0
    s_nop 0
    buffer_load_dwordx4 v20, s[16:19], s32 offen offset:0 lds
    v_mfma_f32_32x32x16_bf16 v[152:167], v[48:51], v[64:67], v[152:167]
    ds_read_b128 v[88:91], v9 offset:16384
    ds_read_b128 v[92:95], v9 offset:20480
    s_add_u32 s38, s32, 7168
    buffer_load_dwordx4 v21, s[16:19], s38 offen offset:1024 lds
    v_mfma_f32_32x32x16_bf16 v[168:183], v[48:51], v[68:71], v[168:183]
    ds_read_b128 v[96:99], v10 offset:16384
    ds_read_b128 v[100:103], v10 offset:20480
    s_add_u32 s38, s32, 14336
    buffer_load_dwordx4 v20, s[16:19], s38 offen offset:2048 lds
    s_waitcnt lgkmcnt(6)
    v_mfma_f32_32x32x16_bf16 v[120:135], v[32:35], v[72:75], v[120:135]
    ds_read_b64_tr_b16 v[44:45], v15 offset:8192
    ds_read_b64_tr_b16 v[46:47], v15 offset:8704
    v_mfma_f32_32x32x16_bf16 v[136:151], v[32:35], v[76:79], v[136:151]
    ds_read_b64_tr_b16 v[48:49], v16 offset:8192
    ds_read_b64_tr_b16 v[50:51], v16 offset:8704
    v_mfma_f32_16x16x32_bf16 v[216:219], v[24:27], v[32:35], v[216:219]
    s_add_u32 s38, s32, 21504
    buffer_load_dwordx4 v21, s[16:19], s38 offen offset:3072 lds
    s_waitcnt lgkmcnt(8)
    v_mfma_f32_32x32x16_bf16 v[152:167], v[36:39], v[72:75], v[152:167]
    ds_read_b128 v[104:107], v11 offset:16384
    ds_read_b128 v[108:111], v11 offset:20480
    s_add_u32 s48, s48, 88064
    s_cmp_ge_u32 s48, s49
    s_cselect_b32 s38, 1409024, 0
    s_sub_u32 s48, s48, s38
    s_add_u32 m0, s43, 32768
    s_nop 0
    buffer_load_dwordx4 v17, s[52:55], s48 offen offset:0 lds
    v_mfma_f32_32x32x16_bf16 v[168:183], v[36:39], v[76:79], v[168:183]
    ds_read_b128 v[112:115], v12 offset:16384
    ds_read_b128 v[116:119], v12 offset:20480
    v_mfma_f32_16x16x32_bf16 v[220:223], v[24:27], v[36:39], v[220:223]
    buffer_load_dwordx4 v18, s[52:55], s48 offen offset:1024 lds
    s_waitcnt vmcnt(13)
    s_waitcnt lgkmcnt(0)
    s_barrier
    v_mfma_f32_32x32x16_bf16 v[120:135], v[44:47], v[80:83], v[120:135]
    ds_read_b64_tr_b16 v[32:33], v13 offset:16384
    ds_read_b64_tr_b16 v[34:35], v13 offset:16896
    v_mfma_f32_32x32x16_bf16 v[136:151], v[44:47], v[84:87], v[136:151]
    ds_read_b64_tr_b16 v[36:37], v14 offset:16384
    ds_read_b64_tr_b16 v[38:39], v14 offset:16896
    s_add_u32 s48, s48, 88064
    s_cmp_ge_u32 s48, s49
    s_cselect_b32 s38, 1409024, 0
    s_sub_u32 s48, s48, s38
    s_add_u32 m0, s43, 40960
    s_nop 0
    buffer_load_dwordx4 v17, s[52:55], s48 offen offset:0 lds
    v_mfma_f32_32x32x16_bf16 v[152:167], v[48:51], v[80:83], v[152:167]
    buffer_load_dwordx4 v18, s[52:55], s48 offen offset:1024 lds
    v_mfma_f32_32x32x16_bf16 v[168:183], v[48:51], v[84:87], v[168:183]
    s_add_u32 s32, s32, 128
    s_bitset0_b32 s32, 10
    s_add_u32 m0, s7, 16384
    s_nop 0
    buffer_load_dwordx4 v20, s[16:19], s32 offen offset:0 lds
    s_waitcnt lgkmcnt(2)
    v_mfma_f32_32x32x16_bf16 v[120:135], v[32:35], v[88:91], v[120:135]
    ds_read_b64_tr_b16 v[44:45], v15 offset:16384
    ds_read_b64_tr_b16 v[46:47], v15 offset:16896
    v_mfma_f32_32x32x16_bf16 v[136:151], v[32:35], v[92:95], v[136:151]
    ds_read_b64_tr_b16 v[48:49], v16 offset:16384
    ds_read_b64_tr_b16 v[50:51], v16 offset:16896
    v_mfma_f32_16x16x32_bf16 v[216:219], v[24:27], v[32:35], v[216:219]
    s_add_u32 s38, s32, 7168
    buffer_load_dwordx4 v21, s[16:19], s38 offen offset:1024 lds
    s_waitcnt lgkmcnt(4)
    v_mfma_f32_32x32x16_bf16 v[152:167], v[36:39], v[88:91], v[152:167]
    s_add_u32 s38, s32, 14336
    buffer_load_dwordx4 v20, s[16:19], s38 offen offset:2048 lds
    v_mfma_f32_32x32x16_bf16 v[168:183], v[36:39], v[92:95], v[168:183]
    v_mfma_f32_16x16x32_bf16 v[220:223], v[24:27], v[36:39], v[220:223]
    s_add_u32 s38, s32, 21504
    buffer_load_dwordx4 v21, s[16:19], s38 offen offset:3072 lds
    s_waitcnt vmcnt(17)
    s_waitcnt vmcnt(8)
    s_waitcnt lgkmcnt(0)
    s_barrier
    v_mfma_f32_32x32x16_bf16 v[120:135], v[44:47], v[96:99], v[120:135]
    ds_read_b64_tr_b16 v[32:33], v13 offset:24576
    ds_read_b64_tr_b16 v[34:35], v13 offset:25088
    v_mfma_f32_32x32x16_bf16 v[136:151], v[44:47], v[100:103], v[136:151]
    ds_read_b64_tr_b16 v[36:37], v14 offset:24576
    ds_read_b64_tr_b16 v[38:39], v14 offset:25088
    v_mfma_f32_32x32x16_bf16 v[152:167], v[48:51], v[96:99], v[152:167]
    ds_read_b128 v[56:59], v9 offset:0
    ds_read_b128 v[60:63], v9 offset:4096
    v_mfma_f32_32x32x16_bf16 v[168:183], v[48:51], v[100:103], v[168:183]
    ds_read_b128 v[64:67], v10 offset:0
    ds_read_b128 v[68:71], v10 offset:4096
    s_add_u32 s48, s48, 88064
    s_cmp_ge_u32 s48, s49
    s_cselect_b32 s38, 1409024, 0
    s_sub_u32 s48, s48, s38
    s_add_u32 m0, s43, 49152
    s_nop 0
    buffer_load_dwordx4 v17, s[52:55], s48 offen offset:0 lds
    s_waitcnt lgkmcnt(6)
    v_mfma_f32_32x32x16_bf16 v[120:135], v[32:35], v[104:107], v[120:135]
    ds_read_b64_tr_b16 v[44:45], v15 offset:24576
    ds_read_b64_tr_b16 v[46:47], v15 offset:25088
    v_mfma_f32_32x32x16_bf16 v[136:151], v[32:35], v[108:111], v[136:151]
    ds_read_b64_tr_b16 v[48:49], v16 offset:24576
    ds_read_b64_tr_b16 v[50:51], v16 offset:25088
    v_mfma_f32_16x16x32_bf16 v[216:219], v[24:27], v[32:35], v[216:219]
    s_waitcnt lgkmcnt(8)
    v_mfma_f32_32x32x16_bf16 v[152:167], v[36:39], v[104:107], v[152:167]
    ds_read_b128 v[72:75], v11 offset:0
    ds_read_b128 v[76:79], v11 offset:4096
    v_mfma_f32_32x32x16_bf16 v[168:183], v[36:39], v[108:111], v[168:183]
    ds_read_b128 v[80:83], v12 offset:0
    ds_read_b128 v[84:87], v12 offset:4096
    v_mfma_f32_16x16x32_bf16 v[220:223], v[24:27], v[36:39], v[220:223]
    buffer_load_dwordx4 v18, s[52:55], s48 offen offset:1024 lds
    s_mov_b32 s92, 200000
tok_l3:
    v_readfirstlane_b32 s90, v252
    v_readfirstlane_b32 s91, v253
    s_cmp_lg_u32 s90, 0
    s_cbranch_scc1 tok_d3
    buffer_load_dwordx2 v[252:253], off, s[60:63], 0 sc0 sc1
    s_waitcnt vmcnt(0)
    s_sub_u32 s92, s92, 1
    s_cmp_lg_u32 s92, 0
    s_cbranch_scc1 tok_l3
tok_d3:
    v_mov_b32 v230, s90
    v_mov_b32 v231, s91
    v_lshrrev_b32 v2, 1, v1
    s_mov_b32 exec_lo, 1
    s_mov_b32 exec_hi, 1
    buffer_store_dwordx4 v[228:231], v2, s[12:15], s35 offen sc0 sc1
    s_mov_b64 exec, -1
    s_waitcnt lgkmcnt(0)
    s_barrier
    v_mfma_f32_32x32x16_bf16 v[120:135], v[44:47], v[112:115], v[120:135]
    ds_read_b64_tr_b16 v[32:33], v13 offset:32768
    ds_read_b64_tr_b16 v[34:35], v13 offset:33280
    v_mfma_f32_32x32x16_bf16 v[136:151], v[44:47], v[116:119], v[136:151]
    ds_read_b64_tr_b16 v[36:37], v14 offset:32768
    ds_read_b64_tr_b16 v[38:39], v14 offset:33280
    s_add_u32 s48, s48, 88064
    s_cmp_ge_u32 s48, s49
    s_cselect_b32 s38, 1409024, 0
    s_sub_u32 s48, s48, s38
    s_add_u32 m0, s43, 57344
    s_nop 0
    buffer_load_dwordx4 v17, s[52:55], s48 offen offset:0 lds
    v_mfma_f32_32x32x16_bf16 v[152:167], v[48:51], v[112:115], v[152:167]
    buffer_load_dwordx4 v18, s[52:55], s48 offen offset:1024 lds
    v_mfma_f32_32x32x16_bf16 v[168:183], v[48:51], v[116:119], v[168:183]
    s_add_u32 s32, s32, 128
    s_bitset0_b32 s32, 10
    s_add_u32 m0, s7, 0
    s_nop 0
    buffer_load_dwordx4 v20, s[16:19], s32 offen offset:0 lds
    s_waitcnt lgkmcnt(2)
    v_mfma_f32_32x32x16_bf16 v[120:135], v[32:35], v[56:59], v[120:135]
    ds_read_b64_tr_b16 v[44:45], v15 offset:32768
    ds_read_b64_tr_b16 v[46:47], v15 offset:33280
    v_mfma_f32_32x32x16_bf16 v[136:151], v[32:35], v[60:63], v[136:151]
    ds_read_b64_tr_b16 v[48:49], v16 offset:32768
    ds_read_b64_tr_b16 v[50:51], v16 offset:33280
    v_mfma_f32_16x16x32_bf16 v[216:219], v[24:27], v[32:35], v[216:219]
    s_add_u32 s38, s32, 7168
    buffer_load_dwordx4 v21, s[16:19], s38 offen offset:1024 lds
    s_waitcnt lgkmcnt(4)
    v_mfma_f32_32x32x16_bf16 v[152:167], v[36:39], v[56:59], v[152:167]
    s_add_u32 s38, s32, 14336
    buffer_load_dwordx4 v20, s[16:19], s38 offen offset:2048 lds
    v_mfma_f32_32x32x16_bf16 v[168:183], v[36:39], v[60:63], v[168:183]
    v_mfma_f32_16x16x32_bf16 v[220:223], v[24:27], v[36:39], v[220:223]
    s_add_u32 s38, s32, 21504
    buffer_load_dwordx4 v21, s[16:19], s38 offen offset:3072 lds
    s_waitcnt vmcnt(9)
    s_waitcnt lgkmcnt(0)
    s_barrier
    v_mfma_f32_32x32x16_bf16 v[120:135], v[44:47], v[64:67], v[120:135]
    ds_read_b64_tr_b16 v[32:33], v13 offset:40960
    ds_read_b64_tr_b16 v[34:35], v13 offset:41472
    v_mfma_f32_32x32x16_bf16 v[136:151], v[44:47], v[68:71], v[136:151]
    ds_read_b64_tr_b16 v[36:37], v14 offset:40960
    ds_read_b64_tr_b16 v[38:39], v14 offset:41472
    v_mfma_f32_32x32x16_bf16 v[152:167], v[48:51], v[64:67], v[152:167]
    ds_read_b128 v[88:91], v9 offset:16384
    ds_read_b128 v[92:95], v9 offset:20480
    v_mfma_f32_32x32x16_bf16 v[168:183], v[48:51], v[68:71], v[168:183]
    ds_read_b128 v[96:99], v10 offset:16384
    ds_read_b128 v[100:103], v10 offset:20480
    s_add_u32 s48, s48, 88064
    s_cmp_ge_u32 s48, s49
    s_cselect_b32 s38, 1409024, 0
    s_sub_u32 s48, s48, s38
    s_add_u32 m0, s43, 65536
    s_nop 0
    buffer_load_dwordx4 v17, s[52:55], s48 offen offset:0 lds
    s_waitcnt lgkmcnt(6)
    v_mfma_f32_32x32x16_bf16 v[120:135], v[32:35], v[72:75], v[120:135]
    ds_read_b64_tr_b16 v[44:45], v15 offset:40960
    ds_read_b64_tr_b16 v[46:47], v15 offset:41472
    v_mfma_f32_32x32x16_bf16 v[136:151], v[32:35], v[76:79], v[136:151]
    ds_read_b64_tr_b16 v[48:49], v16 offset:40960
    ds_read_b64_tr_b16 v[50:51], v16 offset:41472
    v_mfma_f32_16x16x32_bf16 v[216:219], v[24:27], v[32:35], v[216:219]
    s_waitcnt lgkmcnt(8)
    v_mfma_f32_32x32x16_bf16 v[152:167], v[36:39], v[72:75], v[152:167]
    ds_read_b128 v[104:107], v11 offset:16384
    ds_read_b128 v[108:111], v11 offset:20480
    v_mfma_f32_32x32x16_bf16 v[168:183], v[36:39], v[76:79], v[168:183]
    ds_read_b128 v[112:115], v12 offset:16384
    ds_read_b128 v[116:119], v12 offset:20480
    v_mfma_f32_16x16x32_bf16 v[220:223], v[24:27], v[36:39], v[220:223]
    buffer_load_dwordx4 v18, s[52:55], s48 offen offset:1024 lds
    s_waitcnt lgkmcnt(0)
    s_barrier
    v_mfma_f32_32x32x16_bf16 v[120:135], v[44:47], v[80:83], v[120:135]
    ds_read_b64_tr_b16 v[32:33], v13 offset:0
    ds_read_b64_tr_b16 v[34:35], v13 offset:512
    v_mfma_f32_32x32x16_bf16 v[136:151], v[44:47], v[84:87], v[136:151]
    ds_read_b64_tr_b16 v[36:37], v14 offset:0
    ds_read_b64_tr_b16 v[38:39], v14 offset:512
    s_add_u32 s48, s48, 88064
    s_cmp_ge_u32 s48, s49
    s_cselect_b32 s38, 1409024, 0
    s_sub_u32 s48, s48, s38
    s_add_u32 m0, s43, 73728
    s_nop 0
    buffer_load_dwordx4 v17, s[52:55], s48 offen offset:0 lds
    v_mfma_f32_32x32x16_bf16 v[152:167], v[48:51], v[80:83], v[152:167]
    buffer_load_dwordx4 v18, s[52:55], s48 offen offset:1024 lds
    v_mfma_f32_32x32x16_bf16 v[168:183], v[48:51], v[84:87], v[168:183]
    s_add_u32 s32, s32, 128
    s_bitset0_b32 s32, 10
    s_add_u32 m0, s7, 16384
    s_nop 0
    buffer_load_dwordx4 v20, s[16:19], s32 offen offset:0 lds
    s_waitcnt lgkmcnt(2)
    v_mfma_f32_32x32x16_bf16 v[120:135], v[32:35], v[88:91], v[120:135]
    ds_read_b64_tr_b16 v[44:45], v15 offset:0
    ds_read_b64_tr_b16 v[46:47], v15 offset:512
    v_mfma_f32_32x32x16_bf16 v[136:151], v[32:35], v[92:95], v[136:151]
    ds_read_b64_tr_b16 v[48:49], v16 offset:0
    ds_read_b64_tr_b16 v[50:51], v16 offset:512
    v_mfma_f32_16x16x32_bf16 v[216:219], v[24:27], v[32:35], v[216:219]
    s_add_u32 s38, s32, 7168
    buffer_load_dwordx4 v21, s[16:19], s38 offen offset:1024 lds
    s_waitcnt lgkmcnt(4)
    v_mfma_f32_32x32x16_bf16 v[152:167], v[36:39], v[88:91], v[152:167]
    s_add_u32 s38, s32, 14336
    buffer_load_dwordx4 v20, s[16:19], s38 offen offset:2048 lds
    v_mfma_f32_32x32x16_bf16 v[168:183], v[36:39], v[92:95], v[168:183]
    v_mfma_f32_16x16x32_bf16 v[220:223], v[24:27], v[36:39], v[220:223]
    s_add_u32 s38, s32, 21504
    buffer_load_dwordx4 v21, s[16:19], s38 offen offset:3072 lds
    s_waitcnt vmcnt(8)
    s_waitcnt lgkmcnt(0)
    s_barrier
    v_mfma_f32_32x32x16_bf16 v[120:135], v[44:47], v[96:99], v[120:135]
    ds_read_b64_tr_b16 v[32:33], v13 offset:8192
    ds_read_b64_tr_b16 v[34:35], v13 offset:8704
    v_mfma_f32_32x32x16_bf16 v[136:151], v[44:47], v[100:103], v[136:151]
    ds_read_b64_tr_b16 v[36:37], v14 offset:8192
    ds_read_b64_tr_b16 v[38:39], v14 offset:8704
    v_mfma_f32_32x32x16_bf16 v[152:167], v[48:51], v[96:99], v[152:167]
    ds_read_b128 v[56:59], v9 offset:0
    ds_read_b128 v[60:63], v9 offset:4096
    v_mfma_f32_32x32x16_bf16 v[168:183], v[48:51], v[100:103], v[168:183]
    ds_read_b128 v[64:67], v10 offset:0
    ds_read_b128 v[68:71], v10 offset:4096
    s_add_u32 s48, s48, 88064
    s_cmp_ge_u32 s48, s49
    s_cselect_b32 s38, 1409024, 0
    s_sub_u32 s48, s48, s38
    s_add_u32 m0, s43, 32768
    s_nop 0
    buffer_load_dwordx4 v17, s[52:55], s48 offen offset:0 lds
    s_waitcnt lgkmcnt(6)
    v_mfma_f32_32x32x16_bf16 v[120:135], v[32:35], v[104:107], v[120:135]
    ds_read_b64_tr_b16 v[44:45], v15 offset:8192
    ds_read_b64_tr_b16 v[46:47], v15 offset:8704
    v_mfma_f32_32x32x16_bf16 v[136:151], v[32:35], v[108:111], v[136:151]
    ds_read_b64_tr_b16 v[48:49], v16 offset:8192
    ds_read_b64_tr_b16 v[50:51], v16 offset:8704
    v_mfma_f32_16x16x32_bf16 v[216:219], v[24:27], v[32:35], v[216:219]
    s_waitcnt lgkmcnt(8)
    v_mfma_f32_32x32x16_bf16 v[152:167], v[36:39], v[104:107], v[152:167]
    ds_read_b128 v[72:75], v11 offset:0
    ds_read_b128 v[76:79], v11 offset:4096
    v_mfma_f32_32x32x16_bf16 v[168:183], v[36:39], v[108:111], v[168:183]
    ds_read_b128 v[80:83], v12 offset:0
    ds_read_b128 v[84:87], v12 offset:4096
    v_mfma_f32_16x16x32_bf16 v[220:223], v[24:27], v[36:39], v[220:223]
    buffer_load_dwordx4 v18, s[52:55], s48 offen offset:1024 lds
    s_waitcnt lgkmcnt(0)
    s_barrier
    v_mfma_f32_32x32x16_bf16 v[120:135], v[44:47], v[112:115], v[120:135]
    ds_read_b64_tr_b16 v[32:33], v13 offset:16384
    ds_read_b64_tr_b16 v[34:35], v13 offset:16896
    v_mfma_f32_32x32x16_bf16 v[136:151], v[44:47], v[116:119], v[136:151]
    ds_read_b64_tr_b16 v[36:37], v14 offset:16384
    ds_read_b64_tr_b16 v[38:39], v14 offset:16896
    s_add_u32 s48, s48, 88064
    s_cmp_ge_u32 s48, s49
    s_cselect_b32 s38, 1409024, 0
    s_sub_u32 s48, s48, s38
    s_add_u32 m0, s43, 40960
    s_nop 0
    buffer_load_dwordx4 v17, s[52:55], s48 offen offset:0 lds
    v_mfma_f32_32x32x16_bf16 v[152:167], v[48:51], v[112:115], v[152:167]
    buffer_load_dwordx4 v18, s[52:55], s48 offen offset:1024 lds
    v_mfma_f32_32x32x16_bf16 v[168:183], v[48:51], v[116:119], v[168:183]
    s_add_u32 s32, s32, 128
    s_bitset0_b32 s32, 10
    s_add_u32 m0, s7, 0
    s_nop 0
    buffer_load_dwordx4 v20, s[16:19], s32 offen offset:0 lds
    s_waitcnt lgkmcnt(2)
    v_mfma_f32_32x32x16_bf16 v[120:135], v[32:35], v[56:59], v[120:135]
    ds_read_b64_tr_b16 v[44:45], v15 offset:16384
    ds_read_b64_tr_b16 v[46:47], v15 offset:16896
    v_mfma_f32_32x32x16_bf16 v[136:151], v[32:35], v[60:63], v[136:151]
    ds_read_b64_tr_b16 v[48:49], v16 offset:16384
    ds_read_b64_tr_b16 v[50:51], v16 offset:16896
    v_mfma_f32_16x16x32_bf16 v[216:219], v[24:27], v[32:35], v[216:219]
    s_add_u32 s38, s32, 7168
    buffer_load_dwordx4 v21, s[16:19], s38 offen offset:1024 lds
    s_waitcnt lgkmcnt(4)
    v_mfma_f32_32x32x16_bf16 v[152:167], v[36:39], v[56:59], v[152:167]
    s_add_u32 s38, s32, 14336
    buffer_load_dwordx4 v20, s[16:19], s38 offen offset:2048 lds
    v_mfma_f32_32x32x16_bf16 v[168:183], v[36:39], v[60:63], v[168:183]
    v_mfma_f32_16x16x32_bf16 v[220:223], v[24:27], v[36:39], v[220:223]
    s_add_u32 s38, s32, 21504
    buffer_load_dwordx4 v21, s[16:19], s38 offen offset:3072 lds
    s_waitcnt vmcnt(8)
    s_waitcnt lgkmcnt(0)
    s_barrier
    v_mfma_f32_32x32x16_bf16 v[120:135], v[44:47], v[64:67], v[120:135]
    ds_read_b64_tr_b16 v[32:33], v13 offset:24576
    ds_read_b64_tr_b16 v[34:35], v13 offset:25088
    v_mfma_f32_32x32x16_bf16 v[136:151], v[44:47], v[68:71], v[136:151]
    ds_read_b64_tr_b16 v[36:37], v14 offset:24576
    ds_read_b64_tr_b16 v[38:39], v14 offset:25088
    v_mfma_f32_32x32x16_bf16 v[152:167], v[48:51], v[64:67], v[152:167]
    ds_read_b128 v[88:91], v9 offset:16384
    ds_read_b128 v[92:95], v9 offset:20480
    v_mfma_f32_32x32x16_bf16 v[168:183], v[48:51], v[68:71], v[168:183]
    ds_read_b128 v[96:99], v10 offset:16384
    ds_read_b128 v[100:103], v10 offset:20480
    s_add_u32 s48, s48, 88064
    s_cmp_ge_u32 s48, s49
    s_cselect_b32 s38, 1409024, 0
    s_sub_u32 s48, s48, s38
    s_add_u32 m0, s43, 49152
    s_nop 0
    buffer_load_dwordx4 v17, s[52:55], s48 offen offset:0 lds
    s_waitcnt lgkmcnt(6)
    v_mfma_f32_32x32x16_bf16 v[120:135], v[32:35], v[72:75], v[120:135]
    ds_read_b64_tr_b16 v[44:45], v15 offset:24576
    ds_read_b64_tr_b16 v[46:47], v15 offset:25088
    v_mfma_f32_32x32x16_bf16 v[136:151], v[32:35], v[76:79], v[136:151]
    ds_read_b64_tr_b16 v[48:49], v16 offset:24576
    ds_read_b64_tr_b16 v[50:51], v16 offset:25088
    v_mfma_f32_16x16x32_bf16 v[216:219], v[24:27], v[32:35], v[216:219]
    s_waitcnt lgkmcnt(8)
    v_mfma_f32_32x32x16_bf16 v[152:167], v[36:39], v[72:75], v[152:167]
    ds_read_b128 v[104:107], v11 offset:16384
    ds_read_b128 v[108:111], v11 offset:20480
    v_mfma_f32_32x32x16_bf16 v[168:183], v[36:39], v[76:79], v[168:183]
    ds_read_b128 v[112:115], v12 offset:16384
    ds_read_b128 v[116:119], v12 offset:20480
    v_mfma_f32_16x16x32_bf16 v[220:223], v[24:27], v[36:39], v[220:223]
    buffer_load_dwordx4 v18, s[52:55], s48 offen offset:1024 lds
    s_waitcnt lgkmcnt(0)
    s_barrier
    v_mfma_f32_32x32x16_bf16 v[120:135], v[44:47], v[80:83], v[120:135]
    ds_read_b64_tr_b16 v[32:33], v13 offset:32768
    ds_read_b64_tr_b16 v[34:35], v13 offset:33280
    v_mfma_f32_32x32x16_bf16 v[136:151], v[44:47], v[84:87], v[136:151]
    ds_read_b64_tr_b16 v[36:37], v14 offset:32768
    ds_read_b64_tr_b16 v[38:39], v14 offset:33280
    s_add_u32 s48, s48, 88064
    s_cmp_ge_u32 s48, s49
    s_cselect_b32 s38, 1409024, 0
    s_sub_u32 s48, s48, s38
    s_add_u32 m0, s43, 57344
    s_nop 0
    buffer_load_dwordx4 v17, s[52:55], s48 offen offset:0 lds
    v_mfma_f32_32x32x16_bf16 v[152:167], v[48:51], v[80:83], v[152:167]
    buffer_load_dwordx4 v18, s[52:55], s48 offen offset:1024 lds
    v_mfma_f32_32x32x16_bf16 v[168:183], v[48:51], v[84:87], v[168:183]
    s_add_u32 s32, s32, 128
    s_bitset0_b32 s32, 10
    s_add_u32 m0, s7, 16384
    s_nop 0
    buffer_load_dwordx4 v20, s[16:19], s32 offen offset:0 lds
    s_waitcnt lgkmcnt(2)
    v_mfma_f32_32x32x16_bf16 v[120:135], v[32:35], v[88:91], v[120:135]
    ds_read_b64_tr_b16 v[44:45], v15 offset:32768
    ds_read_b64_tr_b16 v[46:47], v15 offset:33280
    v_mfma_f32_32x32x16_bf16 v[136:151], v[32:35], v[92:95], v[136:151]
    ds_read_b64_tr_b16 v[48:49], v16 offset:32768
    ds_read_b64_tr_b16 v[50:51], v16 offset:33280
    v_mfma_f32_16x16x32_bf16 v[216:219], v[24:27], v[32:35], v[216:219]
    s_add_u32 s38, s32, 7168
    buffer_load_dwordx4 v21, s[16:19], s38 offen offset:1024 lds
    s_waitcnt lgkmcnt(4)
    v_mfma_f32_32x32x16_bf16 v[152:167], v[36:39], v[88:91], v[152:167]
    s_add_u32 s38, s32, 14336
    buffer_load_dwordx4 v20, s[16:19], s38 offen offset:2048 lds
    v_mfma_f32_32x32x16_bf16 v[168:183], v[36:39], v[92:95], v[168:183]
    v_mfma_f32_16x16x32_bf16 v[220:223], v[24:27], v[36:39], v[220:223]
    s_add_u32 s38, s32, 21504
    buffer_load_dwordx4 v21, s[16:19], s38 offen offset:3072 lds
    buffer_load_dwordx2 v[232:233], v23, s[16:19], 0 offen offset:0
    buffer_load_dwordx2 v[234:235], v23, s[16:19], 0 offen offset:16
    buffer_load_dwordx2 v[236:237], v23, s[16:19], 0 offen offset:32
    buffer_load_dwordx2 v[238:239], v23, s[16:19], 0 offen offset:48
    s_waitcnt vmcnt(12)
    s_waitcnt lgkmcnt(0)
    s_barrier
    v_mfma_f32_32x32x16_bf16 v[120:135], v[44:47], v[96:99], v[120:135]
    ds_read_b64_tr_b16 v[32:33], v13 offset:40960
    ds_read_b64_tr_b16 v[34:35], v13 offset:41472
    v_mfma_f32_32x32x16_bf16 v[136:151], v[44:47], v[100:103], v[136:151]
    ds_read_b64_tr_b16 v[36:37], v14 offset:40960
    ds_read_b64_tr_b16 v[38:39], v14 offset:41472
    v_mfma_f32_32x32x16_bf16 v[152:167], v[48:51], v[96:99], v[152:167]
    ds_read_b128 v[56:59], v9 offset:0
    ds_read_b128 v[60:63], v9 offset:4096
    v_mfma_f32_32x32x16_bf16 v[168:183], v[48:51], v[100:103], v[168:183]
    ds_read_b128 v[64:67], v10 offset:0
    ds_read_b128 v[68:71], v10 offset:4096
    s_waitcnt lgkmcnt(6)
    v_mfma_f32_32x32x16_bf16 v[120:135], v[32:35], v[104:107], v[120:135]
    ds_read_b64_tr_b16 v[44:45], v15 offset:40960
    ds_read_b64_tr_b16 v[46:47], v15 offset:41472
    v_mfma_f32_32x32x16_bf16 v[136:151], v[32:35], v[108:111], v[136:151]
    ds_read_b64_tr_b16 v[48:49], v16 offset:40960
    ds_read_b64_tr_b16 v[50:51], v16 offset:41472
    v_mfma_f32_16x16x32_bf16 v[216:219], v[24:27], v[32:35], v[216:219]
    s_waitcnt lgkmcnt(8)
    v_mfma_f32_32x32x16_bf16 v[152:167], v[36:39], v[104:107], v[152:167]
    ds_read_b128 v[72:75], v11 offset:0
    ds_read_b128 v[76:79], v11 offset:4096
    v_mfma_f32_32x32x16_bf16 v[168:183], v[36:39], v[108:111], v[168:183]
    ds_read_b128 v[80:83], v12 offset:0
    ds_read_b128 v[84:87], v12 offset:4096
    v_mfma_f32_16x16x32_bf16 v[220:223], v[24:27], v[36:39], v[220:223]
    v_and_b32 v2, 0x1f0, v8
    buffer_load_dwordx4 v[4:7], v8, s[12:15], s46 offen sc0 sc1
    buffer_load_dwordx4 v[28:31], v2, s[12:15], s47 offen sc0 sc1
    s_mul_i32 s38, s33, 344*128
    v_lshlrev_b32 v2, 7, v0
    buffer_load_dword v228, v2, s[8:11], s38 offen
    v_min_u32 v3, 87, v0
    v_lshlrev_b32 v3, 7, v3
    s_add_u32 s38, s38, 256*128
    buffer_load_dword v229, v3, s[8:11], s38 offen
    s_waitcnt lgkmcnt(0)
    s_barrier
    v_mfma_f32_32x32x16_bf16 v[120:135], v[44:47], v[112:115], v[120:135]
    ds_read_b64_tr_b16 v[32:33], v13 offset:0
    ds_read_b64_tr_b16 v[34:35], v13 offset:512
    v_mfma_f32_32x32x16_bf16 v[136:151], v[44:47], v[116:119], v[136:151]
    ds_read_b64_tr_b16 v[36:37], v14 offset:0
    ds_read_b64_tr_b16 v[38:39], v14 offset:512
    v_mfma_f32_32x32x16_bf16 v[152:167], v[48:51], v[112:115], v[152:167]
    v_mfma_f32_32x32x16_bf16 v[168:183], v[48:51], v[116:119], v[168:183]
    s_waitcnt lgkmcnt(2)
    v_mfma_f32_32x32x16_bf16 v[120:135], v[32:35], v[56:59], v[120:135]
    ds_read_b64_tr_b16 v[44:45], v15 offset:0
    ds_read_b64_tr_b16 v[46:47], v15 offset:512
    v_mfma_f32_32x32x16_bf16 v[136:151], v[32:35], v[60:63], v[136:151]
    ds_read_b64_tr_b16 v[48:49], v16 offset:0
    ds_read_b64_tr_b16 v[50:51], v16 offset:512
    v_mfma_f32_16x16x32_bf16 v[216:219], v[24:27], v[32:35], v[216:219]
    s_waitcnt lgkmcnt(4)
    v_mfma_f32_32x32x16_bf16 v[152:167], v[36:39], v[56:59], v[152:167]
    v_mfma_f32_32x32x16_bf16 v[168:183], v[36:39], v[60:63], v[168:183]
    v_mfma_f32_16x16x32_bf16 v[220:223], v[24:27], v[36:39], v[220:223]
    s_waitcnt vmcnt(8)
    s_waitcnt lgkmcnt(0)
    s_barrier
    v_mfma_f32_32x32x16_bf16 v[120:135], v[44:47], v[64:67], v[120:135]
    ds_read_b64_tr_b16 v[32:33], v13 offset:8192
    ds_read_b64_tr_b16 v[34:35], v13 offset:8704
    v_mfma_f32_32x32x16_bf16 v[136:151], v[44:47], v[68:71], v[136:151]
    ds_read_b64_tr_b16 v[36:37], v14 offset:8192
    ds_read_b64_tr_b16 v[38:39], v14 offset:8704
    v_mfma_f32_32x32x16_bf16 v[152:167], v[48:51], v[64:67], v[152:167]
    ds_read_b128 v[88:91], v9 offset:16384
    ds_read_b128 v[92:95], v9 offset:20480
    v_mfma_f32_32x32x16_bf16 v[168:183], v[48:51], v[68:71], v[168:183]
    ds_read_b128 v[96:99], v10 offset:16384
    ds_read_b128 v[100:103], v10 offset:20480
    s_waitcnt lgkmcnt(6)
    v_mfma_f32_32x32x16_bf16 v[120:135], v[32:35], v[72:75], v[120:135]
    ds_read_b64_tr_b16 v[44:45], v15 offset:8192
    ds_read_b64_tr_b16 v[46:47], v15 offset:8704
    v_mfma_f32_32x32x16_bf16 v[136:151], v[32:35], v[76:79], v[136:151]
    ds_read_b64_tr_b16 v[48:49], v16 offset:8192
    ds_read_b64_tr_b16 v[50:51], v16 offset:8704
    v_mfma_f32_16x16x32_bf16 v[216:219], v[24:27], v[32:35], v[216:219]
    s_waitcnt lgkmcnt(8)
    v_mfma_f32_32x32x16_bf16 v[152:167], v[36:39], v[72:75], v[152:167]
    ds_read_b128 v[104:107], v11 offset:16384
    ds_read_b128 v[108:111], v11 offset:20480
    v_mfma_f32_32x32x16_bf16 v[168:183], v[36:39], v[76:79], v[168:183]
    ds_read_b128 v[112:115], v12 offset:16384
    ds_read_b128 v[116:119], v12 offset:20480
    v_mfma_f32_16x16x32_bf16 v[220:223], v[24:27], v[36:39], v[220:223]
    s_waitcnt lgkmcnt(0)
    s_barrier
    v_mfma_f32_32x32x16_bf16 v[120:135], v[44:47], v[80:83], v[120:135]
    ds_read_b64_tr_b16 v[32:33], v13 offset:16384
    ds_read_b64_tr_b16 v[34:35], v13 offset:16896
    v_mfma_f32_32x32x16_bf16 v[136:151], v[44:47], v[84:87], v[136:151]
    ds_read_b64_tr_b16 v[36:37], v14 offset:16384
    ds_read_b64_tr_b16 v[38:39], v14 offset:16896
    v_mfma_f32_32x32x16_bf16 v[152:167], v[48:51], v[80:83], v[152:167]
    v_mfma_f32_32x32x16_bf16 v[168:183], v[48:51], v[84:87], v[168:183]
    s_waitcnt lgkmcnt(2)
    v_mfma_f32_32x32x16_bf16 v[120:135], v[32:35], v[88:91], v[120:135]
    ds_read_b64_tr_b16 v[44:45], v15 offset:16384
    ds_read_b64_tr_b16 v[46:47], v15 offset:16896
    v_mfma_f32_32x32x16_bf16 v[136:151], v[32:35], v[92:95], v[136:151]
    ds_read_b64_tr_b16 v[48:49], v16 offset:16384
    ds_read_b64_tr_b16 v[50:51], v16 offset:16896
    v_mfma_f32_16x16x32_bf16 v[216:219], v[24:27], v[32:35], v[216:219]
    s_waitcnt lgkmcnt(4)
    v_mfma_f32_32x32x16_bf16 v[152:167], v[36:39], v[88:91], v[152:167]
    v_mfma_f32_32x32x16_bf16 v[168:183], v[36:39], v[92:95], v[168:183]
    v_mfma_f32_16x16x32_bf16 v[220:223], v[24:27], v[36:39], v[220:223]
    s_waitcnt lgkmcnt(0)
    s_barrier
    v_mfma_f32_32x32x16_bf16 v[120:135], v[44:47], v[96:99], v[120:135]
    ds_read_b64_tr_b16 v[32:33], v13 offset:24576
    ds_read_b64_tr_b16 v[34:35], v13 offset:25088
    v_mfma_f32_32x32x16_bf16 v[136:151], v[44:47], v[100:103], v[136:151]
    ds_read_b64_tr_b16 v[36:37], v14 offset:24576
    ds_read_b64_tr_b16 v[38:39], v14 offset:25088
    v_mfma_f32_32x32x16_bf16 v[152:167], v[48:51], v[96:99], v[152:167]
    v_mfma_f32_32x32x16_bf16 v[168:183], v[48:51], v[100:103], v[168:183]
    s_waitcnt lgkmcnt(0)
    v_mfma_f32_32x32x16_bf16 v[120:135], v[32:35], v[104:107], v[120:135]
    ds_read_b64_tr_b16 v[44:45], v15 offset:24576
    ds_read_b64_tr_b16 v[46:47], v15 offset:25088
    s_waitcnt vmcnt(2)
    s_mov_b32 s92, 200000
gr_l4:
    v_cmp_ne_u64 vcc, s[90:91], v[6:7]
    v_cmp_ne_u64 s[44:45], s[90:91], v[30:31]
    s_nop 0
    s_or_b64 vcc, vcc, s[44:45]
    s_cbranch_scc0 gr_d4
    v_and_b32 v2, 0x1f0, v8
    buffer_load_dwordx4 v[4:7], v8, s[12:15], s46 offen sc0 sc1
    buffer_load_dwordx4 v[28:31], v2, s[12:15], s47 offen sc0 sc1
    s_waitcnt vmcnt(0)
    s_sub_u32 s92, s92, 1
    s_cmp_lg_u32 s92, 0
    s_cbranch_scc1 gr_l4
gr_d4:
    v_mov_b32 v6, v4
    v_mov_b32 v7, v5
    s_nop 1
    v_permlane32_swap_b32 v4, v6
    v_permlane32_swap_b32 v5, v7
    v_mfma_f32_32x32x16_bf16 v[136:151], v[32:35], v[108:111], v[136:151]
    ds_read_b64_tr_b16 v[48:49], v16 offset:24576
    ds_read_b64_tr_b16 v[50:51], v16 offset:25088
    v_mfma_f32_16x16x32_bf16 v[216:219], v[24:27], v[32:35], v[216:219]
    v_mfma_f32_32x32x16_bf16 v[152:167], v[36:39], v[104:107], v[152:167]
    v_mfma_f32_16x16x32_bf16 v[220:223], v[24:27], v[36:39], v[220:223]
    v_mfma_f32_32x32x16_bf16 v[168:183], v[36:39], v[108:111], v[168:183]
    s_nop 7
    v_and_b32 v2, 31, v1
    v_lshrrev_b32 v3, 5, v1
    v_lshlrev_b32 v2, 2, v2
    v_lshl_add_u32 v2, v3, 12, v2
    s_lshl_b32 s38, s5, 9
    s_add_u32 s38, s38, s37
    v_xor_b32 v2, s38, v2
    ds_write_b32 v2, v216 offset:0
    ds_write_b32 v2, v220 offset:128
    s_waitcnt lgkmcnt(0)
    s_barrier
    s_setprio 3
    v_and_b32 v2, 31, v1
    v_lshrrev_b32 v3, 5, v1
    v_lshlrev_b32 v2, 2, v2
    v_lshl_add_u32 v2, v3, 9, v2
    v_add_u32 v2, s37, v2
    ds_read_b32 v216, v2 offset:0
    ds_read_b32 v217, v2 offset:128
    v_mfma_f32_32x32x16_bf16 v[120:135], v[44:47], v[112:115], v[120:135]
    v_mov_b32 v56, 0
    v_mov_b32 v57, 0
    v_mov_b32 v60, 0
    v_mov_b32 v61, 0
    v_mov_b32 v64, 0
    v_mov_b32 v65, 0
    v_cvt_pk_bf16_f32 v58, v4, v4
    s_add_u32 s38, s41, 327680
    s_add_u32 m0, s37, 8192
    s_nop 0
    buffer_load_dwordx4 v22, s[8:11], s38 offen lds
    s_add_u32 s38, s41, 335872
    s_add_u32 m0, s37, 9216
    s_nop 0
    buffer_load_dwordx4 v22, s[8:11], s38 offen lds
    s_add_u32 s38, s41, 311296
    s_add_u32 m0, s37, 16384
    s_nop 0
    buffer_load_dwordx4 v22, s[8:11], s38 offen lds
    v_mfma_f32_32x32x16_bf16 v[136:151], v[44:47], v[116:119], v[136:151]
    v_cvt_pk_bf16_f32 v59, v4, v4
    v_cvt_pk_bf16_f32 v62, v6, v6
    v_cvt_pk_bf16_f32 v63, v6, v6
    v_mov_b32 v74, 0
    v_mov_b32 v75, 0
    s_add_u32 s43, s42, 88064
    s_waitcnt lgkmcnt(1)
    s_add_u32 s38, s41, 319488
    s_add_u32 m0, s37, 17408
    s_nop 0
    buffer_load_dwordx4 v22, s[8:11], s38 offen lds
    s_add_u32 s38, s41, 294912
    s_add_u32 m0, s37, 24576
    s_nop 0
    buffer_load_dwordx4 v22, s[8:11], s38 offen lds
    s_add_u32 s38, s41, 303104
    s_add_u32 m0, s37, 25600
    s_nop 0
    buffer_load_dwordx4 v22, s[8:11], s38 offen lds
    v_mfma_f32_32x32x16_bf16 v[152:167], v[48:51], v[112:115], v[152:167]
    v_and_b32 v76, s40, v216
    v_sub_f32 v216, v216, v76
    v_and_b32 v77, s40, v216
    v_sub_f32 v216, v216, v77
    v_cvt_pk_bf16_f32 v68, v76, v77
    v_cvt_pk_bf16_f32 v69, v216, 0
    s_waitcnt lgkmcnt(0)
    s_add_u32 s38, s41, 278528
    s_add_u32 m0, s37, 32768
    s_nop 0
    buffer_load_dwordx4 v22, s[8:11], s38 offen lds
    s_add_u32 s38, s41, 286720
    s_add_u32 m0, s37, 33792
    s_nop 0
    buffer_load_dwordx4 v22, s[8:11], s38 offen lds
    s_add_u32 s38, s41, 262144
    s_add_u32 m0, s37, 40960
    s_nop 0
    buffer_load_dwordx4 v22, s[8:11], s38 offen lds
    v_mfma_f32_32x32x16_bf16 v[168:183], v[48:51], v[116:119], v[168:183]
    v_and_b32 v76, s40, v217
    v_sub_f32 v217, v217, v76
    v_and_b32 v77, s40, v217
    v_sub_f32 v217, v217, v77
    v_cvt_pk_bf16_f32 v70, v76, v77
    v_cvt_pk_bf16_f32 v71, v217, 0
    s_add_u32 s38, s41, 270336
    s_add_u32 m0, s37, 41984
    s_nop 0
    buffer_load_dwordx4 v22, s[8:11], s38 offen lds
    s_add_u32 s38, s41, 245760
    s_add_u32 m0, s37, 49152
    s_nop 0
    buffer_load_dwordx4 v22, s[8:11], s38 offen lds
    s_add_u32 s38, s41, 253952
    s_add_u32 m0, s37, 50176
    s_nop 0
    buffer_load_dwordx4 v22, s[8:11], s38 offen lds
    s_nop 1
    v_mfma_f32_32x32x16_bf16 v[120:135], v[68:71], v[58:61], v[120:135]
    v_mfma_f32_32x32x16_bf16 v[136:151], v[68:71], v[62:65], v[136:151]
    v_mfma_f32_32x32x16_bf16 v[152:167], v[68:71], v[56:59], v[152:167]
    v_mul_f32 v120, v120, v5
    v_mul_f32 v121, v121, v5
    v_mul_f32 v122, v122, v5
    v_mul_f32 v123, v123, v5
    v_mul_f32 v124, v124, v5
    v_mul_f32 v125, v125, v5
    v_mul_f32 v126, v126, v5
    v_mfma_f32_32x32x16_bf16 v[168:183], v[68:71], v[60:63], v[168:183]
    v_mul_f32 v127, v127, v5
    v_mul_f32 v128, v128, v5
    v_mul_f32 v129, v129, v5
    v_mul_f32 v130, v130, v5
    v_mul_f32 v131, v131, v5
    v_mul_f32 v132, v132, v5
    v_mul_f32 v133, v133, v5
    v_mul_f32 v134, v134, v5
    v_mul_f32 v135, v135, v5
    v_cvt_pk_bf16_f32 v120, 0, v120
    v_cvt_pk_bf16_f32 v121, 0, v121
    v_cvt_pk_bf16_f32 v122, 0, v122
    v_cvt_pk_bf16_f32 v123, 0, v123
    v_cvt_pk_bf16_f32 v124, 0, v124
    v_cvt_pk_bf16_f32 v125, 0, v125
    v_cvt_pk_bf16_f32 v126, 0, v126
    v_cvt_pk_bf16_f32 v127, 0, v127
    v_cvt_pk_bf16_f32 v128, 0, v128
    v_cvt_pk_bf16_f32 v129, 0, v129
    v_cvt_pk_bf16_f32 v130, 0, v130
    v_cvt_pk_bf16_f32 v131, 0, v131
    v_cvt_pk_bf16_f32 v132, 0, v132
    v_cvt_pk_bf16_f32 v133, 0, v133
    v_cvt_pk_bf16_f32 v134, 0, v134
    v_cvt_pk_bf16_f32 v135, 0, v135
    v_mul_f32 v120, v120, v128
    v_mul_f32 v121, v121, v129
    v_mul_f32 v122, v122, v130
    v_mul_f32 v123, v123, v131
    v_mul_f32 v124, v124, v132
    v_mul_f32 v125, v125, v133
    v_mul_f32 v126, v126, v134
    v_mul_f32 v127, v127, v135
    v_cvt_pk_bf16_f32 v128, v120, v121
    v_cvt_pk_bf16_f32 v129, v122, v123
    v_cvt_pk_bf16_f32 v130, v124, v125
    v_cvt_pk_bf16_f32 v131, v126, v127
    s_nop 1
    v_permlane32_swap_b32 v128, v130
    v_permlane32_swap_b32 v129, v131
    buffer_store_dwordx4 v[128:131], v8, s[24:27], s42 offen offset:0 sc0 sc1
    v_mul_f32 v136, v136, v7
    v_mul_f32 v137, v137, v7
    v_mul_f32 v138, v138, v7
    v_mul_f32 v139, v139, v7
    v_mul_f32 v140, v140, v7
    v_mul_f32 v141, v141, v7
    v_mul_f32 v142, v142, v7
    v_mul_f32 v143, v143, v7
    v_mul_f32 v144, v144, v7
    v_mul_f32 v145, v145, v7
    v_mul_f32 v146, v146, v7
    v_mul_f32 v147, v147, v7
    v_mul_f32 v148, v148, v7
    v_mul_f32 v149, v149, v7
    v_mul_f32 v150, v150, v7
    v_mul_f32 v151, v151, v7
    v_cvt_pk_bf16_f32 v136, 0, v136
    v_cvt_pk_bf16_f32 v137, 0, v137
    v_cvt_pk_bf16_f32 v138, 0, v138
    v_cvt_pk_bf16_f32 v139, 0, v139
    v_cvt_pk_bf16_f32 v140, 0, v140
    v_cvt_pk_bf16_f32 v141, 0, v141
    v_cvt_pk_bf16_f32 v142, 0, v142
    v_cvt_pk_bf16_f32 v143, 0, v143
    v_cvt_pk_bf16_f32 v144, 0, v144
    v_cvt_pk_bf16_f32 v145, 0, v145
    v_cvt_pk_bf16_f32 v146, 0, v146
    v_cvt_pk_bf16_f32 v147, 0, v147
    v_cvt_pk_bf16_f32 v148, 0, v148
    v_cvt_pk_bf16_f32 v149, 0, v149
    v_cvt_pk_bf16_f32 v150, 0, v150
    v_cvt_pk_bf16_f32 v151, 0, v151
    v_mul_f32 v136, v136, v144
    v_mul_f32 v137, v137, v145
    v_mul_f32 v138, v138, v146
    v_mul_f32 v139, v139, v147
    v_mul_f32 v140, v140, v148
    v_mul_f32 v141, v141, v149
    v_mul_f32 v142, v142, v150
    v_mul_f32 v143, v143, v151
    v_cvt_pk_bf16_f32 v144, v136, v137
    v_cvt_pk_bf16_f32 v145, v138, v139
    v_cvt_pk_bf16_f32 v146, v140, v141
    v_cvt_pk_bf16_f32 v147, v142, v143
    s_nop 1
    v_permlane32_swap_b32 v144, v146
    v_permlane32_swap_b32 v145, v147
    buffer_store_dwordx4 v[144:147], v8, s[24:27], s43 offen offset:0 sc0 sc1
    v_mul_f32 v152, v152, v5
    v_mul_f32 v153, v153, v5
    v_mul_f32 v154, v154, v5
    v_mul_f32 v155, v155, v5
    v_mul_f32 v156, v156, v5
    v_mul_f32 v157, v157, v5
    v_mul_f32 v158, v158, v5
    v_mul_f32 v159, v159, v5
    v_mul_f32 v160, v160, v5
    v_mul_f32 v161, v161, v5
    v_mul_f32 v162, v162, v5
    v_mul_f32 v163, v163, v5
    v_mul_f32 v164, v164, v5
    v_mul_f32 v165, v165, v5
    v_mul_f32 v166, v166, v5
    v_mul_f32 v167, v167, v5
    v_cvt_pk_bf16_f32 v152, 0, v152
    v_cvt_pk_bf16_f32 v153, 0, v153
    v_cvt_pk_bf16_f32 v154, 0, v154
    v_cvt_pk_bf16_f32 v155, 0, v155
    v_cvt_pk_bf16_f32 v156, 0, v156
    v_cvt_pk_bf16_f32 v157, 0, v157
    v_cvt_pk_bf16_f32 v158, 0, v158
    v_cvt_pk_bf16_f32 v159, 0, v159
    v_cvt_pk_bf16_f32 v160, 0, v160
    v_cvt_pk_bf16_f32 v161, 0, v161
    v_cvt_pk_bf16_f32 v162, 0, v162
    v_cvt_pk_bf16_f32 v163, 0, v163
    v_cvt_pk_bf16_f32 v164, 0, v164
    v_cvt_pk_bf16_f32 v165, 0, v165
    v_cvt_pk_bf16_f32 v166, 0, v166
    v_cvt_pk_bf16_f32 v167, 0, v167
    v_mul_f32 v152, v152, v160
    v_mul_f32 v153, v153, v161
    v_mul_f32 v154, v154, v162
    v_mul_f32 v155, v155, v163
    v_mul_f32 v156, v156, v164
    v_mul_f32 v157, v157, v165
    v_mul_f32 v158, v158, v166
    v_mul_f32 v159, v159, v167
    v_cvt_pk_bf16_f32 v160, v152, v153
    v_cvt_pk_bf16_f32 v161, v154, v155
    v_cvt_pk_bf16_f32 v162, v156, v157
    v_cvt_pk_bf16_f32 v163, v158, v159
    s_nop 1
    v_permlane32_swap_b32 v160, v162
    v_permlane32_swap_b32 v161, v163
    buffer_store_dwordx4 v[160:163], v8, s[24:27], s42 offen offset:1024 sc0 sc1
    v_mul_f32 v168, v168, v7
    v_mul_f32 v169, v169, v7
    v_mul_f32 v170, v170, v7
    v_mul_f32 v171, v171, v7
    v_mul_f32 v172, v172, v7
    v_mul_f32 v173, v173, v7
    v_mul_f32 v174, v174, v7
    v_mul_f32 v175, v175, v7
    v_mul_f32 v176, v176, v7
    v_mul_f32 v177, v177, v7
    v_mul_f32 v178, v178, v7
    v_mul_f32 v179, v179, v7
    v_mul_f32 v180, v180, v7
    v_mul_f32 v181, v181, v7
    v_mul_f32 v182, v182, v7
    v_mul_f32 v183, v183, v7
    v_cvt_pk_bf16_f32 v168, 0, v168
    v_cvt_pk_bf16_f32 v169, 0, v169
    v_cvt_pk_bf16_f32 v170, 0, v170
    v_cvt_pk_bf16_f32 v171, 0, v171
    v_cvt_pk_bf16_f32 v172, 0, v172
    v_cvt_pk_bf16_f32 v173, 0, v173
    v_cvt_pk_bf16_f32 v174, 0, v174
    v_cvt_pk_bf16_f32 v175, 0, v175
    v_cvt_pk_bf16_f32 v176, 0, v176
    v_cvt_pk_bf16_f32 v177, 0, v177
    v_cvt_pk_bf16_f32 v178, 0, v178
    v_cvt_pk_bf16_f32 v179, 0, v179
    v_cvt_pk_bf16_f32 v180, 0, v180
    v_cvt_pk_bf16_f32 v181, 0, v181
    v_cvt_pk_bf16_f32 v182, 0, v182
    v_cvt_pk_bf16_f32 v183, 0, v183
    v_mul_f32 v168, v168, v176
    v_mul_f32 v169, v169, v177
    v_mul_f32 v170, v170, v178
    v_mul_f32 v171, v171, v179
    v_mul_f32 v172, v172, v180
    v_mul_f32 v173, v173, v181
    v_mul_f32 v174, v174, v182
    v_mul_f32 v175, v175, v183
    v_cvt_pk_bf16_f32 v176, v168, v169
    v_cvt_pk_bf16_f32 v177, v170, v171
    v_cvt_pk_bf16_f32 v178, v172, v173
    v_cvt_pk_bf16_f32 v179, v174, v175
    s_nop 1
    v_permlane32_swap_b32 v176, v178
    v_permlane32_swap_b32 v177, v179
    buffer_store_dwordx4 v[176:179], v8, s[24:27], s43 offen offset:1024 sc0 sc1
    s_branch phase_c
phase_c:
    v_lshrrev_b32 v3, 5, v1
    v_and_b32 v5, 15, v1
    s_mov_b32 s30, s4
    s_and_b32 s31, s33, 7
    s_and_b32 s32, s3, 1
    s_lshr_b32 s33, s3, 1
    s_add_u32 s38, s41, 344064
    s_add_u32 m0, s37, 0
    s_nop 0
    buffer_load_dwordx4 v22, s[8:11], s38 offen lds
    s_add_u32 s38, s41, 352256
    s_add_u32 m0, s37, 1024
    s_nop 0
    buffer_load_dwordx4 v22, s[8:11], s38 offen lds
    s_add_u32 s38, s41, 229376
    s_add_u32 m0, s37, 57344
    s_nop 0
    buffer_load_dwordx4 v22, s[8:11], s38 offen lds
    s_add_u32 s38, s41, 237568
    s_add_u32 m0, s37, 58368
    s_nop 0
    buffer_load_dwordx4 v22, s[8:11], s38 offen lds
    s_add_u32 s38, s41, 212992
    s_add_u32 m0, s37, 65536
    s_nop 0
    buffer_load_dwordx4 v22, s[8:11], s38 offen lds
    s_add_u32 s38, s41, 221184
    s_add_u32 m0, s37, 66560
    s_nop 0
    buffer_load_dwordx4 v22, s[8:11], s38 offen lds
    s_add_u32 s38, s41, 196608
    s_add_u32 m0, s37, 73728
    s_nop 0
    buffer_load_dwordx4 v22, s[8:11], s38 offen lds
    s_add_u32 s38, s41, 204800
    s_add_u32 m0, s37, 74752
    s_nop 0
    buffer_load_dwordx4 v22, s[8:11], s38 offen lds
    s_lshl_b32 s35, s30, 1
    s_add_u32 s35, s35, s32
    v_lshlrev_b32 v15, 7, v1
    v_lshrrev_b32 v6, 2, v5
    v_lshl_add_u32 v6, v3, 3, v6
    v_lshlrev_b32 v11, 7, v6
    v_bfe_u32 v6, v1, 4, 1
    v_lshlrev_b32 v6, 5, v6
    v_and_b32 v7, 3, v5
    v_lshl_add_u32 v6, v7, 3, v6
    v_bfe_u32 v7, v1, 3, 1
    v_lshlrev_b32 v7, 6, v7
    v_xor_b32 v6, v6, v7
    v_add_u32 v11, v11, v6
    v_add_u32 v11, s37, v11
    s_lshl_b32 s38, s33, 6
    v_xor_b32 v11, s38, v11
    v_xor_b32 v12, 64, v11
    v_add_u32 v17, 40960, v11
    v_add_u32 v18, 40960, v12
    s_add_u32 s20, s88, 4194304
    s_addc_u32 s21, s89, 0
    s_and_b32 s21, s21, 0xffff
    s_mov_b32 s22, 5636096
    s_mov_b32 s23, 0x00020000
    s_add_u32 s44, s88, 10485760
    s_addc_u32 s45, s89, 0
    s_and_b32 s45, s45, 0xffff
    s_mov_b32 s46, 2097152
    s_mov_b32 s47, 0x00020000
    s_mov_b32 s52, s84
    s_and_b32 s53, s85, 0xffff
    s_mov_b32 s54, 2097152
    s_mov_b32 s55, 0x00020000
    s_lshr_b32 s49, s30, 4
    s_lshl_b32 s49, s49, 12
    s_lshl_b32 s38, s31, 9
    s_add_u32 s49, s49, s38
    s_lshl_b32 s38, s33, 8
    s_add_u32 s49, s49, s38
    s_add_u32 s49, s49, 24576
    v_lshrrev_b32 v0, 2, v1
    v_lshlrev_b32 v0, 12, v0
    v_and_b32 v7, 3, v1
    v_lshl_add_u32 v0, v7, 4, v0
    s_lshl_b32 s38, s31, 1
    s_add_u32 s38, s38, s33
    s_lshl_b32 s38, s38, 17
    s_lshl_b32 s48, s35, 6
    s_add_u32 s48, s48, s38
    v_lshrrev_b32 v7, 2, v5
    v_lshl_add_u32 v7, v3, 2, v7
    v_lshlrev_b32 v14, 6, v7
    v_bfe_u32 v7, v1, 4, 1
    v_lshl_add_u32 v14, v7, 5, v14
    v_and_b32 v7, 3, v5
    v_lshl_add_u32 v14, v7, 3, v14
    v_add_u32 v14, s37, v14
    s_mul_i32 s42, s30, 176128
    s_lshl_b32 s38, s51, 10
    s_add_u32 s42, s42, s38
    s_mov_b32 s29, s42
    s_lshl_b32 s38, s33, 10
    s_sub_u32 s42, s42, s38
    s_add_u32 s42, s42, 18*1024
    s_add_u32 s43, s42, 88064
    s_mov_b32 s38, s42
    s_cmp_eq_u32 s32, 1
    s_cselect_b32 s42, s43, s42
    s_cselect_b32 s43, s38, s43
    s_lshl_b32 s36, s30, 8
    s_add_u32 s36, s36, 16384
    s_mov_b32 s50, 0xf000f
    s_cmp_eq_u32 s3, 1
    s_cselect_b32 s50, 0xf000f0, s50
    s_cmp_eq_u32 s3, 2
    s_cselect_b32 s50, 0xf000f00, s50
    s_cmp_eq_u32 s3, 3
    s_cselect_b32 s50, 0xf800f800, s50
    s_mov_b32 s51, 0
    s_mov_b32 s12, 0xc000c
    s_cmp_eq_u32 s3, 1
    s_cselect_b32 s12, 0xc000c0, s12
    s_cmp_eq_u32 s3, 2
    s_cselect_b32 s12, 0xc000c00, s12
    s_cmp_eq_u32 s3, 3
    s_cselect_b32 s12, 0xe000e000, s12
    s_mov_b32 s13, 0
    s_mov_b32 s14, 0xe000e
    s_cmp_eq_u32 s3, 1
    s_cselect_b32 s14, 0xe000e0, s14
    s_cmp_eq_u32 s3, 2
    s_cselect_b32 s14, 0xe000e00, s14
    s_cmp_eq_u32 s3, 3
    s_cselect_b32 s14, 0xf000f000, s14
    s_mov_b32 s15, 0
    s_mov_b64 s[16:17], s[50:51]
    s_lshl_b32 s66, s3, 2
    s_lshl_b32 s66, 0x80008, s66
    s_mov_b32 s67, 0
    s_mul_i32 s38, s31, 44
    v_add_u32 v6, s38, v1
    v_cmp_le_u32 vcc, 176, v6
    v_subrev_u32 v7, 176, v6
    v_cndmask_b32 v6, v6, v7, vcc
    s_cmp_lt_u32 s3, 2
    s_cselect_b32 s38, 8, 0
    s_add_u32 s38, s38, 167
    v_min_u32 v6, s38, v6
    v_lshlrev_b32 v6, 7, v6
    v_mov_b32 v7, 88064
    v_cndmask_b32 v7, 0, v7, vcc
    v_add_u32 v6, v6, v7
    s_waitcnt vmcnt(8)
    s_lshl_b32 s93, s39, 4
    s_mov_b64 exec, 1
    buffer_store_dwordx2 v[252:253], off, s[56:59], s93 sc0 sc1
    s_mov_b64 exec, -1
    v_lshlrev_b32 v88, 16, v232
    v_and_b32 v89, s40, v232
    v_lshlrev_b32 v90, 16, v233
    v_and_b32 v91, s40, v233
    v_lshlrev_b32 v92, 16, v234
    v_and_b32 v93, s40, v234
    v_lshlrev_b32 v94, 16, v235
    v_and_b32 v95, s40, v235
    v_lshlrev_b32 v96, 16, v236
    v_and_b32 v97, s40, v236
    v_lshlrev_b32 v98, 16, v237
    v_and_b32 v99, s40, v237
    v_lshlrev_b32 v100, 16, v238
    v_and_b32 v101, s40, v238
    v_lshlrev_b32 v102, 16, v239
    v_and_b32 v103, s40, v239
    v_add_f32 v88, v88, v28
    v_add_f32 v89, v89, v28
    v_add_f32 v90, v90, v28
    v_add_f32 v91, v91, v28
    v_add_f32 v92, v92, v28
    v_add_f32 v93, v93, v28
    v_add_f32 v94, v94, v28
    v_add_f32 v95, v95, v28
    v_add_f32 v96, v96, v28
    v_add_f32 v97, v97, v28
    v_add_f32 v98, v98, v28
    v_add_f32 v99, v99, v28
    v_add_f32 v100, v100, v28
    v_add_f32 v101, v101, v28
    v_add_f32 v102, v102, v28
    v_add_f32 v103, v103, v28
    v_cvt_pk_bf16_f32 v88, 0, v88
    v_cvt_pk_bf16_f32 v89, 0, v89
    v_cvt_pk_bf16_f32 v90, 0, v90
    v_cvt_pk_bf16_f32 v91, 0, v91
    v_cvt_pk_bf16_f32 v92, 0, v92
    v_cvt_pk_bf16_f32 v93, 0, v93
    v_cvt_pk_bf16_f32 v94, 0, v94
    v_cvt_pk_bf16_f32 v95, 0, v95
    v_cvt_pk_bf16_f32 v96, 0, v96
    v_cvt_pk_bf16_f32 v97, 0, v97
    v_cvt_pk_bf16_f32 v98, 0, v98
    v_cvt_pk_bf16_f32 v99, 0, v99
    v_cvt_pk_bf16_f32 v100, 0, v100
    v_cvt_pk_bf16_f32 v101, 0, v101
    v_cvt_pk_bf16_f32 v102, 0, v102
    v_cvt_pk_bf16_f32 v103, 0, v103
    v_mul_f32 v88, v88, v29
    v_mul_f32 v89, v89, v29
    v_mul_f32 v90, v90, v29
    v_mul_f32 v91, v91, v29
    v_mul_f32 v92, v92, v29
    v_mul_f32 v93, v93, v29
    v_mul_f32 v94, v94, v29
    v_mul_f32 v95, v95, v29
    v_mul_f32 v96, v96, v29
    v_mul_f32 v97, v97, v29
    v_mul_f32 v98, v98, v29
    v_mul_f32 v99, v99, v29
    v_mul_f32 v100, v100, v29
    v_mul_f32 v101, v101, v29
    v_mul_f32 v102, v102, v29
    v_mul_f32 v103, v103, v29
    v_cvt_pk_bf16_f32 v72, v88, v89
    v_cvt_pk_bf16_f32 v73, v90, v91
    v_cvt_pk_bf16_f32 v74, v92, v93
    v_cvt_pk_bf16_f32 v75, v94, v95
    v_cvt_pk_bf16_f32 v76, v96, v97
    v_cvt_pk_bf16_f32 v77, v98, v99
    v_cvt_pk_bf16_f32 v78, v100, v101
    v_cvt_pk_bf16_f32 v79, v102, v103
    s_waitcnt vmcnt(7)
    ds_read_b64_tr_b16 v[216:217], v11 offset:0
    ds_read_b64_tr_b16 v[218:219], v11 offset:512
    ds_read_b64_tr_b16 v[220:221], v12 offset:0
    ds_read_b64_tr_b16 v[222:223], v12 offset:512
    ds_read_b64_tr_b16 v[224:225], v11 offset:8192
    ds_read_b64_tr_b16 v[226:227], v11 offset:8704
    ds_read_b64_tr_b16 v[228:229], v12 offset:8192
    ds_read_b64_tr_b16 v[230:231], v12 offset:8704
    ds_read_b64_tr_b16 v[80:81], v11 offset:16384
    ds_read_b64_tr_b16 v[82:83], v11 offset:16896
    ds_read_b64_tr_b16 v[84:85], v12 offset:16384
    ds_read_b64_tr_b16 v[86:87], v12 offset:16896
    ds_read_b64_tr_b16 v[240:241], v11 offset:24576
    ds_read_b64_tr_b16 v[242:243], v11 offset:25088
    ds_read_b64_tr_b16 v[244:245], v12 offset:24576
    ds_read_b64_tr_b16 v[246:247], v12 offset:25088
    ds_read_b64_tr_b16 v[32:33], v11 offset:32768
    ds_read_b64_tr_b16 v[34:35], v11 offset:33280
    ds_read_b64_tr_b16 v[36:37], v12 offset:32768
    ds_read_b64_tr_b16 v[38:39], v12 offset:33280
    ds_read_b64_tr_b16 v[40:41], v17 offset:0
    ds_read_b64_tr_b16 v[42:43], v17 offset:512
    ds_read_b64_tr_b16 v[44:45], v18 offset:0
    ds_read_b64_tr_b16 v[46:47], v18 offset:512
    s_waitcnt lgkmcnt(15)
    s_add_u32 s38, s41, 180224
    s_add_u32 m0, s37, 0
    s_nop 0
    buffer_load_dwordx4 v22, s[8:11], s38 offen lds
    s_add_u32 s38, s41, 188416
    s_add_u32 m0, s37, 1024
    s_nop 0
    buffer_load_dwordx4 v22, s[8:11], s38 offen lds
    s_waitcnt lgkmcnt(15)
    s_add_u32 s38, s41, 163840
    s_add_u32 m0, s37, 8192
    s_nop 0
    buffer_load_dwordx4 v22, s[8:11], s38 offen lds
    s_add_u32 s38, s41, 172032
    s_add_u32 m0, s37, 9216
    s_nop 0
    buffer_load_dwordx4 v22, s[8:11], s38 offen lds
    s_waitcnt lgkmcnt(12)
    s_add_u32 s38, s41, 147456
    s_add_u32 m0, s37, 16384
    s_nop 0
    buffer_load_dwordx4 v22, s[8:11], s38 offen lds
    s_add_u32 s38, s41, 155648
    s_add_u32 m0, s37, 17408
    s_nop 0
    buffer_load_dwordx4 v22, s[8:11], s38 offen lds
    s_waitcnt lgkmcnt(8)
    s_add_u32 s38, s41, 131072
    s_add_u32 m0, s37, 24576
    s_nop 0
    buffer_load_dwordx4 v22, s[8:11], s38 offen lds
    s_add_u32 s38, s41, 139264
    s_add_u32 m0, s37, 25600
    s_nop 0
    buffer_load_dwordx4 v22, s[8:11], s38 offen lds
    s_waitcnt lgkmcnt(4)
    s_add_u32 s38, s41, 114688
    s_add_u32 m0, s37, 32768
    s_nop 0
    buffer_load_dwordx4 v22, s[8:11], s38 offen lds
    s_add_u32 s38, s41, 122880
    s_add_u32 m0, s37, 33792
    s_nop 0
    buffer_load_dwordx4 v22, s[8:11], s38 offen lds
    s_lshl_b32 s93, s36, 4
    s_mov_b64 exec, s[50:51]
    buffer_load_dwordx2 v[250:251], v15, s[56:59], s93 offen sc0 sc1
    s_mov_b64 exec, -1
    s_waitcnt lgkmcnt(0)
    s_add_u32 s38, s41, 98304
    s_add_u32 m0, s37, 40960
    s_nop 0
    buffer_load_dwordx4 v22, s[8:11], s38 offen lds
    s_add_u32 s38, s41, 106496
    s_add_u32 m0, s37, 41984
    s_nop 0
    buffer_load_dwordx4 v22, s[8:11], s38 offen lds
    s_setprio 0
    s_waitcnt vmcnt(2)
    s_mov_b64 exec, s[50:51]
    v_cmp_ne_u64 s[16:17], s[90:91], v[250:251]
    s_mov_b64 exec, -1
    s_and_b64 s[18:19], s[16:17], s[66:67]
    s_cbranch_scc0 pg_d5
    s_mov_b32 s92, 200000
    s_lshl_b32 s93, s36, 4
pg_l5:
    s_mov_b64 exec, s[16:17]
    buffer_load_dwordx2 v[250:251], v15, s[56:59], s93 offen sc0 sc1
    s_waitcnt vmcnt(0)
    v_cmp_ne_u64 s[16:17], s[90:91], v[250:251]
    s_and_b64 s[18:19], s[16:17], s[66:67]
    s_cbranch_scc0 pg_e5
    s_sleep 2
    s_sub_u32 s92, s92, 1
    s_cmp_lg_u32 s92, 0
    s_cbranch_scc1 pg_l5
pg_e5:
    s_mov_b64 exec, -1
pg_d5:
    buffer_load_dwordx4 v[152:155], v8, s[20:23], s42 offen offset:3072
    buffer_load_dwordx4 v[156:159], v8, s[20:23], s43 offen offset:3072
    buffer_load_dwordx4 v[160:163], v8, s[20:23], s42 offen offset:2048
    buffer_load_dwordx4 v[164:167], v8, s[20:23], s43 offen offset:2048
    buffer_load_dwordx4 v[168:171], v8, s[20:23], s42 offen offset:1024
    buffer_load_dwordx4 v[172:175], v8, s[20:23], s43 offen offset:1024
    s_and_b64 s[18:19], s[16:17], s[12:13]
    s_cbranch_scc0 pg_d6
    s_mov_b32 s92, 200000
    s_lshl_b32 s93, s36, 4
pg_l6:
    s_mov_b64 exec, s[16:17]
    buffer_load_dwordx2 v[250:251], v15, s[56:59], s93 offen sc0 sc1
    s_waitcnt vmcnt(0)
    v_cmp_ne_u64 s[16:17], s[90:91], v[250:251]
    s_and_b64 s[18:19], s[16:17], s[12:13]
    s_cbranch_scc0 pg_e6
    s_sleep 2
    s_sub_u32 s92, s92, 1
    s_cmp_lg_u32 s92, 0
    s_cbranch_scc1 pg_l6
pg_e6:
    s_mov_b64 exec, -1
pg_d6:
    buffer_load_dwordx4 v[176:179], v8, s[20:23], s42 offen offset:0
    buffer_load_dwordx4 v[180:183], v8, s[20:23], s43 offen offset:0
    s_sub_u32 s42, s42, 4096
    s_sub_u32 s43, s43, 4096
    buffer_load_dwordx4 v[184:187], v8, s[20:23], s42 offen offset:3072
    buffer_load_dwordx4 v[188:191], v8, s[20:23], s43 offen offset:3072
    buffer_load_dwordx4 v[192:195], v8, s[20:23], s42 offen offset:2048
    buffer_load_dwordx4 v[196:199], v8, s[20:23], s43 offen offset:2048
    s_lshl_b32 s93, s36, 4
    s_mov_b64 exec, s[50:51]
    buffer_load_dwordx2 v[250:251], v15, s[56:59], s93 offen sc0 sc1
    s_mov_b64 exec, -1
    buffer_load_dwordx4 v[200:203], v8, s[20:23], s42 offen offset:1024
    buffer_load_dwordx4 v[204:207], v8, s[20:23], s43 offen offset:1024
    buffer_load_dwordx4 v[208:211], v8, s[20:23], s42 offen offset:0
    buffer_load_dwordx4 v[212:215], v8, s[20:23], s43 offen offset:0
    s_sub_u32 s42, s42, 4096
    s_sub_u32 s43, s43, 4096
    buffer_load_dwordx4 v[64:67], v8, s[20:23], s42 offen offset:3072
    buffer_load_dwordx4 v[68:71], v8, s[20:23], s43 offen offset:3072
    s_waitcnt vmcnt(17)
    v_mfma_f32_32x32x16_bf16 v[88:103], v[216:219], v[152:155], 0
    v_mfma_f32_32x32x16_bf16 v[104:119], v[216:219], v[156:159], 0
    v_mfma_f32_32x32x16_bf16 v[120:135], v[220:223], v[152:155], 0
    v_mfma_f32_32x32x16_bf16 v[136:151], v[220:223], v[156:159], 0
    s_waitcnt vmcnt(6)
    s_mov_b64 exec, s[50:51]
    v_cmp_ne_u64 s[16:17], s[90:91], v[250:251]
    s_mov_b64 exec, -1
    s_and_b64 s[18:19], s[16:17], s[14:15]
    s_cbranch_scc0 pg_d7
    s_mov_b32 s92, 200000
    s_lshl_b32 s93, s36, 4
pg_l7:
    s_mov_b64 exec, s[16:17]
    buffer_load_dwordx2 v[250:251], v15, s[56:59], s93 offen sc0 sc1
    s_waitcnt vmcnt(0)
    v_cmp_ne_u64 s[16:17], s[90:91], v[250:251]
    s_and_b64 s[18:19], s[16:17], s[14:15]
    s_cbranch_scc0 pg_e7
    s_sleep 2
    s_sub_u32 s92, s92, 1
    s_cmp_lg_u32 s92, 0
    s_cbranch_scc1 pg_l7
pg_e7:
    s_mov_b64 exec, -1
pg_d7:
    s_lshl_b32 s93, s36, 4
    s_mov_b64 exec, s[50:51]
    buffer_load_dwordx2 v[250:251], v15, s[56:59], s93 offen sc0 sc1
    s_mov_b64 exec, -1
    buffer_load_dwordx4 v[152:155], v8, s[20:23], s42 offen offset:2048
    buffer_load_dwordx4 v[156:159], v8, s[20:23], s43 offen offset:2048
    buffer_load_dwordx4 v[216:219], v8, s[20:23], s42 offen offset:1024
    buffer_load_dwordx4 v[220:223], v8, s[20:23], s43 offen offset:1024
    v_mfma_f32_32x32x16_bf16 v[88:103], v[224:227], v[160:163], v[88:103]
    v_mfma_f32_32x32x16_bf16 v[104:119], v[224:227], v[164:167], v[104:119]
    v_mfma_f32_32x32x16_bf16 v[120:135], v[228:231], v[160:163], v[120:135]
    v_mfma_f32_32x32x16_bf16 v[136:151], v[228:231], v[164:167], v[136:151]
    buffer_load_dwordx4 v[160:163], v8, s[20:23], s42 offen offset:0
    buffer_load_dwordx4 v[164:167], v8, s[20:23], s43 offen offset:0
    s_sub_u32 s42, s42, 4096
    s_sub_u32 s43, s43, 4096
    buffer_load_dwordx4 v[224:227], v8, s[20:23], s42 offen offset:3072
    buffer_load_dwordx4 v[228:231], v8, s[20:23], s43 offen offset:3072
    v_mfma_f32_32x32x16_bf16 v[88:103], v[80:83], v[168:171], v[88:103]
    v_mfma_f32_32x32x16_bf16 v[104:119], v[80:83], v[172:175], v[104:119]
    v_mfma_f32_32x32x16_bf16 v[120:135], v[84:87], v[168:171], v[120:135]
    v_mfma_f32_32x32x16_bf16 v[136:151], v[84:87], v[172:175], v[136:151]
    buffer_load_dwordx4 v[168:171], v8, s[20:23], s42 offen offset:2048
    buffer_load_dwordx4 v[172:175], v8, s[20:23], s43 offen offset:2048
    buffer_load_dwordx4 v[80:83], v8, s[20:23], s42 offen offset:1024
    buffer_load_dwordx4 v[84:87], v8, s[20:23], s43 offen offset:1024
    v_mfma_f32_32x32x16_bf16 v[88:103], v[240:243], v[176:179], v[88:103]
    v_mfma_f32_32x32x16_bf16 v[104:119], v[240:243], v[180:183], v[104:119]
    v_mfma_f32_32x32x16_bf16 v[120:135], v[244:247], v[176:179], v[120:135]
    v_mfma_f32_32x32x16_bf16 v[136:151], v[244:247], v[180:183], v[136:151]
    s_waitcnt vmcnt(12)
    s_mov_b64 exec, s[50:51]
    v_cmp_ne_u64 s[16:17], s[90:91], v[250:251]
    s_mov_b64 exec, -1
    s_and_b64 s[18:19], s[16:17], s[50:51]
    s_cbranch_scc0 pg_d8
    s_mov_b32 s92, 200000
    s_lshl_b32 s93, s36, 4
pg_l8:
    s_mov_b64 exec, s[16:17]
    buffer_load_dwordx2 v[250:251], v15, s[56:59], s93 offen sc0 sc1
    s_waitcnt vmcnt(0)
    v_cmp_ne_u64 s[16:17], s[90:91], v[250:251]
    s_and_b64 s[18:19], s[16:17], s[50:51]
    s_cbranch_scc0 pg_e8
    s_sleep 2
    s_sub_u32 s92, s92, 1
    s_cmp_lg_u32 s92, 0
    s_cbranch_scc1 pg_l8
pg_e8:
    s_mov_b64 exec, -1
pg_d8:
    buffer_load_dwordx4 v[176:179], v8, s[20:23], s42 offen offset:0
    buffer_load_dwordx4 v[180:183], v8, s[20:23], s43 offen offset:0
    s_sub_u32 s42, s42, 4096
    s_sub_u32 s43, s43, 4096
    buffer_load_dwordx4 v[240:243], v8, s[20:23], s42 offen offset:3072
    buffer_load_dwordx4 v[244:247], v8, s[20:23], s43 offen offset:3072
    v_mfma_f32_32x32x16_bf16 v[88:103], v[32:35], v[184:187], v[88:103]
    v_mfma_f32_32x32x16_bf16 v[104:119], v[32:35], v[188:191], v[104:119]
    v_mfma_f32_32x32x16_bf16 v[120:135], v[36:39], v[184:187], v[120:135]
    v_mfma_f32_32x32x16_bf16 v[136:151], v[36:39], v[188:191], v[136:151]
    buffer_load_dwordx4 v[184:187], v8, s[20:23], s42 offen offset:2048
    buffer_load_dwordx4 v[188:191], v8, s[20:23], s43 offen offset:2048
    buffer_load_dwordx4 v[32:35], v8, s[20:23], s42 offen offset:1024
    buffer_load_dwordx4 v[36:39], v8, s[20:23], s43 offen offset:1024
    ds_read_b64_tr_b16 v[48:49], v17 offset:8192
    ds_read_b64_tr_b16 v[50:51], v17 offset:8704
    ds_read_b64_tr_b16 v[52:53], v18 offset:8192
    ds_read_b64_tr_b16 v[54:55], v18 offset:8704
    v_mfma_f32_32x32x16_bf16 v[88:103], v[40:43], v[192:195], v[88:103]
    v_mfma_f32_32x32x16_bf16 v[104:119], v[40:43], v[196:199], v[104:119]
    v_mfma_f32_32x32x16_bf16 v[120:135], v[44:47], v[192:195], v[120:135]
    v_mfma_f32_32x32x16_bf16 v[136:151], v[44:47], v[196:199], v[136:151]
    buffer_load_dwordx4 v[192:195], v8, s[20:23], s42 offen offset:0
    buffer_load_dwordx4 v[196:199], v8, s[20:23], s43 offen offset:0
    s_sub_u32 s42, s42, 2048
    s_sub_u32 s43, s43, 2048
    buffer_load_dwordx4 v[40:43], v8, s[20:23], s42 offen offset:1024
    buffer_load_dwordx4 v[44:47], v8, s[20:23], s43 offen offset:1024
    s_waitcnt lgkmcnt(0)
    ds_read_b64_tr_b16 v[56:57], v17 offset:16384
    ds_read_b64_tr_b16 v[58:59], v17 offset:16896
    ds_read_b64_tr_b16 v[60:61], v18 offset:16384
    ds_read_b64_tr_b16 v[62:63], v18 offset:16896
    v_mfma_f32_32x32x16_bf16 v[88:103], v[48:51], v[200:203], v[88:103]
    v_mfma_f32_32x32x16_bf16 v[104:119], v[48:51], v[204:207], v[104:119]
    v_mfma_f32_32x32x16_bf16 v[120:135], v[52:55], v[200:203], v[120:135]
    v_mfma_f32_32x32x16_bf16 v[136:151], v[52:55], v[204:207], v[136:151]
    s_lshl_b32 s38, s33, 10
    s_add_u32 s42, s42, s38
    s_add_u32 s43, s43, s38
    buffer_load_dwordx4 v[200:203], v8, s[20:23], s42 offen offset:0
    buffer_load_dwordx4 v[204:207], v8, s[20:23], s43 offen offset:0
    s_add_u32 s38, s41, 81920
    s_add_u32 m0, s37, 49152
    s_nop 0
    buffer_load_dwordx4 v22, s[8:11], s38 offen lds
    s_add_u32 s38, s41, 90112
    s_add_u32 m0, s37, 50176
    s_nop 0
    buffer_load_dwordx4 v22, s[8:11], s38 offen lds
    s_waitcnt lgkmcnt(0)
    ds_read_b64_tr_b16 v[48:49], v17 offset:24576
    ds_read_b64_tr_b16 v[50:51], v17 offset:25088
    ds_read_b64_tr_b16 v[52:53], v18 offset:24576
    ds_read_b64_tr_b16 v[54:55], v18 offset:25088
    v_mfma_f32_32x32x16_bf16 v[88:103], v[56:59], v[208:211], v[88:103]
    v_mfma_f32_32x32x16_bf16 v[104:119], v[56:59], v[212:215], v[104:119]
    v_mfma_f32_32x32x16_bf16 v[120:135], v[60:63], v[208:211], v[120:135]
    v_mfma_f32_32x32x16_bf16 v[136:151], v[60:63], v[212:215], v[136:151]
    s_add_u32 s38, s41, 65536
    s_add_u32 m0, s37, 57344
    s_nop 0
    buffer_load_dwordx4 v22, s[8:11], s38 offen lds
    s_add_u32 s38, s41, 73728
    s_add_u32 m0, s37, 58368
    s_nop 0
    buffer_load_dwordx4 v22, s[8:11], s38 offen lds
    s_waitcnt lgkmcnt(0)
    ds_read_b64_tr_b16 v[56:57], v17 offset:32768
    ds_read_b64_tr_b16 v[58:59], v17 offset:33280
    ds_read_b64_tr_b16 v[60:61], v18 offset:32768
    ds_read_b64_tr_b16 v[62:63], v18 offset:33280
    v_mfma_f32_32x32x16_bf16 v[88:103], v[48:51], v[64:67], v[88:103]
    v_mfma_f32_32x32x16_bf16 v[104:119], v[48:51], v[68:71], v[104:119]
    v_mfma_f32_32x32x16_bf16 v[120:135], v[52:55], v[64:67], v[120:135]
    v_mfma_f32_32x32x16_bf16 v[136:151], v[52:55], v[68:71], v[136:151]
    s_add_u32 s38, s41, 49152
    s_add_u32 m0, s37, 65536
    s_nop 0
    buffer_load_dwordx4 v22, s[8:11], s38 offen lds
    s_add_u32 s38, s41, 57344
    s_add_u32 m0, s37, 66560
    s_nop 0
    buffer_load_dwordx4 v22, s[8:11], s38 offen lds
    s_waitcnt vmcnt(30)
    s_waitcnt lgkmcnt(0)
    ds_read_b64_tr_b16 v[48:49], v11 offset:0
    ds_read_b64_tr_b16 v[50:51], v11 offset:512
    ds_read_b64_tr_b16 v[52:53], v12 offset:0
    ds_read_b64_tr_b16 v[54:55], v12 offset:512
    v_mfma_f32_32x32x16_bf16 v[88:103], v[56:59], v[152:155], v[88:103]
    v_mfma_f32_32x32x16_bf16 v[104:119], v[56:59], v[156:159], v[104:119]
    v_mfma_f32_32x32x16_bf16 v[120:135], v[60:63], v[152:155], v[120:135]
    v_mfma_f32_32x32x16_bf16 v[136:151], v[60:63], v[156:159], v[136:151]
    s_add_u32 s38, s41, 32768
    s_add_u32 m0, s37, 73728
    s_nop 0
    buffer_load_dwordx4 v22, s[8:11], s38 offen lds
    s_add_u32 s38, s41, 40960
    s_add_u32 m0, s37, 74752
    s_nop 0
    buffer_load_dwordx4 v22, s[8:11], s38 offen lds
    s_waitcnt vmcnt(30)
    s_waitcnt lgkmcnt(0)
    ds_read_b64_tr_b16 v[56:57], v11 offset:8192
    ds_read_b64_tr_b16 v[58:59], v11 offset:8704
    ds_read_b64_tr_b16 v[60:61], v12 offset:8192
    ds_read_b64_tr_b16 v[62:63], v12 offset:8704
    v_mfma_f32_32x32x16_bf16 v[88:103], v[48:51], v[216:219], v[88:103]
    v_mfma_f32_32x32x16_bf16 v[104:119], v[48:51], v[220:223], v[104:119]
    v_mfma_f32_32x32x16_bf16 v[120:135], v[52:55], v[216:219], v[120:135]
    v_mfma_f32_32x32x16_bf16 v[136:151], v[52:55], v[220:223], v[136:151]
    s_waitcnt vmcnt(28)
    s_waitcnt lgkmcnt(0)
    ds_read_b64_tr_b16 v[48:49], v11 offset:16384
    ds_read_b64_tr_b16 v[50:51], v11 offset:16896
    ds_read_b64_tr_b16 v[52:53], v12 offset:16384
    ds_read_b64_tr_b16 v[54:55], v12 offset:16896
    v_mfma_f32_32x32x16_bf16 v[88:103], v[56:59], v[160:163], v[88:103]
    v_mfma_f32_32x32x16_bf16 v[104:119], v[56:59], v[164:167], v[104:119]
    v_mfma_f32_32x32x16_bf16 v[120:135], v[60:63], v[160:163], v[120:135]
    v_mfma_f32_32x32x16_bf16 v[136:151], v[60:63], v[164:167], v[136:151]
    s_add_u32 s38, s41, 16384
    s_add_u32 m0, s37, 8192
    s_nop 0
    buffer_load_dwordx4 v22, s[8:11], s38 offen lds
    s_add_u32 s38, s41, 24576
    s_add_u32 m0, s37, 9216
    s_nop 0
    buffer_load_dwordx4 v22, s[8:11], s38 offen lds
    s_waitcnt vmcnt(28)
    s_waitcnt lgkmcnt(0)
    ds_read_b64_tr_b16 v[56:57], v11 offset:24576
    ds_read_b64_tr_b16 v[58:59], v11 offset:25088
    ds_read_b64_tr_b16 v[60:61], v12 offset:24576
    ds_read_b64_tr_b16 v[62:63], v12 offset:25088
    v_mfma_f32_32x32x16_bf16 v[88:103], v[48:51], v[224:227], v[88:103]
    v_mfma_f32_32x32x16_bf16 v[104:119], v[48:51], v[228:231], v[104:119]
    v_mfma_f32_32x32x16_bf16 v[120:135], v[52:55], v[224:227], v[120:135]
    v_mfma_f32_32x32x16_bf16 v[136:151], v[52:55], v[228:231], v[136:151]
    s_add_u32 s38, s41, 0
    s_add_u32 m0, s37, 16384
    s_nop 0
    buffer_load_dwordx4 v22, s[8:11], s38 offen lds
    s_add_u32 s38, s41, 8192
    s_add_u32 m0, s37, 17408
    s_nop 0
    buffer_load_dwordx4 v22, s[8:11], s38 offen lds
    s_waitcnt vmcnt(28)
    s_waitcnt lgkmcnt(0)
    ds_read_b64_tr_b16 v[48:49], v11 offset:32768
    ds_read_b64_tr_b16 v[50:51], v11 offset:33280
    ds_read_b64_tr_b16 v[52:53], v12 offset:32768
    ds_read_b64_tr_b16 v[54:55], v12 offset:33280
    v_mfma_f32_32x32x16_bf16 v[88:103], v[56:59], v[168:171], v[88:103]
    v_mfma_f32_32x32x16_bf16 v[104:119], v[56:59], v[172:175], v[104:119]
    v_mfma_f32_32x32x16_bf16 v[120:135], v[60:63], v[168:171], v[120:135]
    v_mfma_f32_32x32x16_bf16 v[136:151], v[60:63], v[172:175], v[136:151]
    s_waitcnt vmcnt(26)
    s_waitcnt lgkmcnt(0)
    ds_read_b64_tr_b16 v[56:57], v17 offset:0
    ds_read_b64_tr_b16 v[58:59], v17 offset:512
    ds_read_b64_tr_b16 v[60:61], v18 offset:0
    ds_read_b64_tr_b16 v[62:63], v18 offset:512
    v_mfma_f32_32x32x16_bf16 v[88:103], v[48:51], v[80:83], v[88:103]
    v_mfma_f32_32x32x16_bf16 v[104:119], v[48:51], v[84:87], v[104:119]
    v_mfma_f32_32x32x16_bf16 v[120:135], v[52:55], v[80:83], v[120:135]
    v_mfma_f32_32x32x16_bf16 v[136:151], v[52:55], v[84:87], v[136:151]
    s_waitcnt vmcnt(24)
    s_waitcnt lgkmcnt(0)
    s_waitcnt vmcnt(10)
    ds_read_b64_tr_b16 v[48:49], v17 offset:8192
    ds_read_b64_tr_b16 v[50:51], v17 offset:8704
    ds_read_b64_tr_b16 v[52:53], v18 offset:8192
    ds_read_b64_tr_b16 v[54:55], v18 offset:8704
    v_mfma_f32_32x32x16_bf16 v[88:103], v[56:59], v[176:179], v[88:103]
    v_mfma_f32_32x32x16_bf16 v[104:119], v[56:59], v[180:183], v[104:119]
    v_mfma_f32_32x32x16_bf16 v[120:135], v[60:63], v[176:179], v[120:135]
    v_mfma_f32_32x32x16_bf16 v[136:151], v[60:63], v[180:183], v[136:151]
    s_waitcnt lgkmcnt(0)
    s_waitcnt vmcnt(8)
    ds_read_b64_tr_b16 v[56:57], v17 offset:16384
    ds_read_b64_tr_b16 v[58:59], v17 offset:16896
    ds_read_b64_tr_b16 v[60:61], v18 offset:16384
    ds_read_b64_tr_b16 v[62:63], v18 offset:16896
    v_mfma_f32_32x32x16_bf16 v[88:103], v[48:51], v[240:243], v[88:103]
    v_mfma_f32_32x32x16_bf16 v[104:119], v[48:51], v[244:247], v[104:119]
    v_mfma_f32_32x32x16_bf16 v[120:135], v[52:55], v[240:243], v[120:135]
    v_mfma_f32_32x32x16_bf16 v[136:151], v[52:55], v[244:247], v[136:151]
    s_lshl_b32 s93, s49, 4
    s_mov_b32 exec_hi, 0
    buffer_load_dwordx2 v[248:249], v15, s[56:59], s93 offen sc0 sc1
    s_mov_b64 exec, -1
    s_waitcnt lgkmcnt(0)
    s_waitcnt vmcnt(7)
    ds_read_b64_tr_b16 v[48:49], v17 offset:24576
    ds_read_b64_tr_b16 v[50:51], v17 offset:25088
    ds_read_b64_tr_b16 v[52:53], v18 offset:24576
    ds_read_b64_tr_b16 v[54:55], v18 offset:25088
    v_mfma_f32_32x32x16_bf16 v[88:103], v[56:59], v[184:187], v[88:103]
    v_mfma_f32_32x32x16_bf16 v[104:119], v[56:59], v[188:191], v[104:119]
    v_mfma_f32_32x32x16_bf16 v[120:135], v[60:63], v[184:187], v[120:135]
    v_mfma_f32_32x32x16_bf16 v[136:151], v[60:63], v[188:191], v[136:151]
    s_waitcnt lgkmcnt(0)
    s_waitcnt vmcnt(5)
    ds_read_b64_tr_b16 v[56:57], v17 offset:32768
    ds_read_b64_tr_b16 v[58:59], v17 offset:33280
    ds_read_b64_tr_b16 v[60:61], v18 offset:32768
    ds_read_b64_tr_b16 v[62:63], v18 offset:33280
    v_mfma_f32_32x32x16_bf16 v[88:103], v[48:51], v[32:35], v[88:103]
    v_mfma_f32_32x32x16_bf16 v[104:119], v[48:51], v[36:39], v[104:119]
    v_mfma_f32_32x32x16_bf16 v[120:135], v[52:55], v[32:35], v[120:135]
    v_mfma_f32_32x32x16_bf16 v[136:151], v[52:55], v[36:39], v[136:151]
    s_waitcnt lgkmcnt(0)
    s_waitcnt vmcnt(3)
    ds_read_b64_tr_b16 v[48:49], v11 offset:8192
    ds_read_b64_tr_b16 v[50:51], v11 offset:8704
    ds_read_b64_tr_b16 v[52:53], v12 offset:8192
    ds_read_b64_tr_b16 v[54:55], v12 offset:8704
    v_mfma_f32_32x32x16_bf16 v[88:103], v[56:59], v[192:195], v[88:103]
    v_mfma_f32_32x32x16_bf16 v[104:119], v[56:59], v[196:199], v[104:119]
    v_mfma_f32_32x32x16_bf16 v[120:135], v[60:63], v[192:195], v[120:135]
    v_mfma_f32_32x32x16_bf16 v[136:151], v[60:63], v[196:199], v[136:151]
    s_waitcnt lgkmcnt(0)
    s_waitcnt vmcnt(1)
    ds_read_b64_tr_b16 v[56:57], v11 offset:16384
    ds_read_b64_tr_b16 v[58:59], v11 offset:16896
    ds_read_b64_tr_b16 v[60:61], v12 offset:16384
    ds_read_b64_tr_b16 v[62:63], v12 offset:16896
    v_mfma_f32_32x32x16_bf16 v[88:103], v[48:51], v[40:43], v[88:103]
    v_mfma_f32_32x32x16_bf16 v[104:119], v[48:51], v[44:47], v[104:119]
    v_mfma_f32_32x32x16_bf16 v[120:135], v[52:55], v[40:43], v[120:135]
    v_mfma_f32_32x32x16_bf16 v[136:151], v[52:55], v[44:47], v[136:151]
    s_waitcnt vmcnt(0)
    s_mov_b32 exec_hi, 0
    v_cmp_ne_u64 vcc, s[90:91], v[248:249]
    s_mov_b64 exec, -1
    s_cmp_eq_u64 vcc, 0
    s_cselect_b32 s28, 1, 0
    s_cbranch_scc0 fy_no
    s_add_u32 s38, s48, 0
    s_add_u32 m0, s37, 0
    s_nop 0
    buffer_load_dwordx4 v0, s[44:47], s38 offen lds
    s_add_u32 s38, s48, 65536
    s_add_u32 m0, s37, 1024
    s_nop 0
    buffer_load_dwordx4 v0, s[44:47], s38 offen lds
fy_no:
    s_cmp_ge_u32 s3, 2
    s_cbranch_scc1 pc_skip
    s_waitcnt lgkmcnt(0)
    v_mfma_f32_32x32x16_bf16 v[88:103], v[56:59], v[200:203], v[88:103]
    v_mfma_f32_32x32x16_bf16 v[104:119], v[56:59], v[204:207], v[104:119]
    v_mfma_f32_32x32x16_bf16 v[120:135], v[60:63], v[200:203], v[120:135]
    v_mfma_f32_32x32x16_bf16 v[136:151], v[60:63], v[204:207], v[136:151]
pc_skip:
    s_waitcnt vmcnt(2) lgkmcnt(0)
    s_xor_b32 s36, s3, 1
    s_lshl_b32 s38, s36, 14
    s_add_u32 s38, s38, s37
    v_add_u32 v9, s38, v8
    s_lshl_b32 s36, s36, 11
    s_lshl_b32 s38, s3, 14
    s_add_u32 s38, s38, s36
    v_add_u32 v16, s38, v8
    s_xor_b32 s36, s3, 2
    s_lshl_b32 s38, s36, 14
    s_add_u32 s38, s38, s37
    v_add_u32 v10, s38, v8
    s_lshl_b32 s36, s36, 11
    s_lshl_b32 s38, s3, 14
    s_add_u32 s38, s38, s36
    v_add_u32 v17, s38, v8
    s_xor_b32 s36, s3, 3
    s_lshl_b32 s38, s36, 14
    s_add_u32 s38, s38, s37
    v_add_u32 v11, s38, v8
    s_lshl_b32 s36, s36, 11
    s_lshl_b32 s38, s3, 14
    s_add_u32 s38, s38, s36
    v_add_u32 v18, s38, v8
    s_cmp_eq_u32 s28, 0
    s_cbranch_scc1 fin_slow
    s_nop 7
    ds_write_b128 v9, v[104:107] offset:16384
    v_lshlrev_b32 v216, 16, v232
    v_and_b32 v217, s40, v232
    ds_write_b128 v9, v[108:111] offset:17408
    v_lshlrev_b32 v218, 16, v233
    v_and_b32 v219, s40, v233
    ds_write_b128 v9, v[112:115] offset:24576
    v_lshlrev_b32 v220, 16, v234
    v_and_b32 v221, s40, v234
    ds_write_b128 v9, v[116:119] offset:25600
    v_lshlrev_b32 v222, 16, v235
    v_and_b32 v223, s40, v235
    ds_write_b128 v10, v[120:123] offset:16384
    v_lshlrev_b32 v224, 16, v236
    v_and_b32 v225, s40, v236
    ds_write_b128 v10, v[124:127] offset:17408
    v_lshlrev_b32 v226, 16, v237
    v_and_b32 v227, s40, v237
    ds_write_b128 v10, v[128:131] offset:24576
    v_lshlrev_b32 v228, 16, v238
    v_and_b32 v229, s40, v238
    ds_write_b128 v10, v[132:135] offset:25600
    v_lshlrev_b32 v230, 16, v239
    v_and_b32 v231, s40, v239
    ds_write_b128 v11, v[136:139] offset:16384
    ds_write_b128 v11, v[140:143] offset:17408
    ds_write_b128 v11, v[144:147] offset:24576
    ds_write_b128 v11, v[148:151] offset:25600
    s_waitcnt lgkmcnt(0)
    s_barrier
    ds_read_b128 v[168:171], v16 offset:16384
    ds_read_b128 v[172:175], v16 offset:17408
    ds_read_b128 v[176:179], v16 offset:24576
    ds_read_b128 v[180:183], v16 offset:25600
    ds_read_b128 v[184:187], v17 offset:16384
    ds_read_b128 v[188:191], v17 offset:17408
    ds_read_b128 v[192:195], v17 offset:24576
    ds_read_b128 v[196:199], v17 offset:25600
    ds_read_b128 v[200:203], v18 offset:16384
    ds_read_b128 v[204:207], v18 offset:17408
    ds_read_b128 v[208:211], v18 offset:24576
    ds_read_b128 v[212:215], v18 offset:25600
    s_waitcnt vmcnt(0)
    ds_read_b64_tr_b16 v[32:33], v14 offset:0
    ds_read_b64_tr_b16 v[34:35], v14 offset:512
    ds_read_b64_tr_b16 v[36:37], v14 offset:1024
    ds_read_b64_tr_b16 v[38:39], v14 offset:1536
    s_waitcnt lgkmcnt(12)
    v_pk_add_f32 v[152:153], v[88:89], v[168:169]
    v_pk_add_f32 v[154:155], v[90:91], v[170:171]
    v_pk_add_f32 v[156:157], v[92:93], v[172:173]
    v_pk_add_f32 v[158:159], v[94:95], v[174:175]
    v_pk_add_f32 v[160:161], v[96:97], v[176:177]
    v_pk_add_f32 v[162:163], v[98:99], v[178:179]
    v_pk_add_f32 v[164:165], v[100:101], v[180:181]
    v_pk_add_f32 v[166:167], v[102:103], v[182:183]
    s_waitcnt lgkmcnt(4)
    v_pk_add_f32 v[184:185], v[184:185], v[200:201]
    v_pk_add_f32 v[186:187], v[186:187], v[202:203]
    v_pk_add_f32 v[188:189], v[188:189], v[204:205]
    v_pk_add_f32 v[190:191], v[190:191], v[206:207]
    v_pk_add_f32 v[192:193], v[192:193], v[208:209]
    v_pk_add_f32 v[194:195], v[194:195], v[210:211]
    v_pk_add_f32 v[196:197], v[196:197], v[212:213]
    v_pk_add_f32 v[198:199], v[198:199], v[214:215]
    v_pk_add_f32 v[152:153], v[152:153], v[184:185]
    v_pk_add_f32 v[154:155], v[154:155], v[186:187]
    v_pk_add_f32 v[156:157], v[156:157], v[188:189]
    v_pk_add_f32 v[158:159], v[158:159], v[190:191]
    v_pk_add_f32 v[160:161], v[160:161], v[192:193]
    v_pk_add_f32 v[162:163], v[162:163], v[194:195]
    v_pk_add_f32 v[164:165], v[164:165], v[196:197]
    v_pk_add_f32 v[166:167], v[166:167], v[198:199]
    v_cvt_pk_bf16_f32 v152, 0, v152
    v_cvt_pk_bf16_f32 v153, 0, v153
    v_cvt_pk_bf16_f32 v154, 0, v154
    v_cvt_pk_bf16_f32 v155, 0, v155
    v_cvt_pk_bf16_f32 v156, 0, v156
    v_cvt_pk_bf16_f32 v157, 0, v157
    v_cvt_pk_bf16_f32 v158, 0, v158
    v_cvt_pk_bf16_f32 v159, 0, v159
    v_cvt_pk_bf16_f32 v160, 0, v160
    v_cvt_pk_bf16_f32 v161, 0, v161
    v_cvt_pk_bf16_f32 v162, 0, v162
    v_cvt_pk_bf16_f32 v163, 0, v163
    v_cvt_pk_bf16_f32 v164, 0, v164
    v_cvt_pk_bf16_f32 v165, 0, v165
    v_cvt_pk_bf16_f32 v166, 0, v166
    v_cvt_pk_bf16_f32 v167, 0, v167
    s_waitcnt lgkmcnt(0)
    v_lshlrev_b32 v64, 16, v72
    v_and_b32 v65, s40, v72
    v_lshlrev_b32 v66, 16, v73
    v_and_b32 v67, s40, v73
    v_lshlrev_b32 v68, 16, v32
    v_and_b32 v69, s40, v32
    v_lshlrev_b32 v70, 16, v33
    v_and_b32 v71, s40, v33
    v_pk_mul_f32 v[64:65], v[64:65], v[68:69]
    v_pk_mul_f32 v[66:67], v[66:67], v[70:71]
    v_cvt_pk_bf16_f32 v64, 0, v64
    v_cvt_pk_bf16_f32 v65, 0, v65
    v_cvt_pk_bf16_f32 v66, 0, v66
    v_cvt_pk_bf16_f32 v67, 0, v67
    v_pk_add_f32 v[216:217], v[216:217], v[64:65]
    v_pk_add_f32 v[218:219], v[218:219], v[66:67]
    v_cvt_pk_bf16_f32 v216, 0, v216
    v_cvt_pk_bf16_f32 v217, 0, v217
    v_cvt_pk_bf16_f32 v218, 0, v218
    v_cvt_pk_bf16_f32 v219, 0, v219
    v_lshlrev_b32 v64, 16, v74
    v_and_b32 v65, s40, v74
    v_lshlrev_b32 v66, 16, v75
    v_and_b32 v67, s40, v75
    v_lshlrev_b32 v68, 16, v34
    v_and_b32 v69, s40, v34
    v_lshlrev_b32 v70, 16, v35
    v_and_b32 v71, s40, v35
    v_pk_mul_f32 v[64:65], v[64:65], v[68:69]
    v_pk_mul_f32 v[66:67], v[66:67], v[70:71]
    v_cvt_pk_bf16_f32 v64, 0, v64
    v_cvt_pk_bf16_f32 v65, 0, v65
    v_cvt_pk_bf16_f32 v66, 0, v66
    v_cvt_pk_bf16_f32 v67, 0, v67
    v_pk_add_f32 v[220:221], v[220:221], v[64:65]
    v_pk_add_f32 v[222:223], v[222:223], v[66:67]
    v_cvt_pk_bf16_f32 v220, 0, v220
    v_cvt_pk_bf16_f32 v221, 0, v221
    v_cvt_pk_bf16_f32 v222, 0, v222
    v_cvt_pk_bf16_f32 v223, 0, v223
    v_lshlrev_b32 v64, 16, v76
    v_and_b32 v65, s40, v76
    v_lshlrev_b32 v66, 16, v77
    v_and_b32 v67, s40, v77
    v_lshlrev_b32 v68, 16, v36
    v_and_b32 v69, s40, v36
    v_lshlrev_b32 v70, 16, v37
    v_and_b32 v71, s40, v37
    v_pk_mul_f32 v[64:65], v[64:65], v[68:69]
    v_pk_mul_f32 v[66:67], v[66:67], v[70:71]
    v_cvt_pk_bf16_f32 v64, 0, v64
    v_cvt_pk_bf16_f32 v65, 0, v65
    v_cvt_pk_bf16_f32 v66, 0, v66
    v_cvt_pk_bf16_f32 v67, 0, v67
    v_pk_add_f32 v[224:225], v[224:225], v[64:65]
    v_pk_add_f32 v[226:227], v[226:227], v[66:67]
    v_cvt_pk_bf16_f32 v224, 0, v224
    v_cvt_pk_bf16_f32 v225, 0, v225
    v_cvt_pk_bf16_f32 v226, 0, v226
    v_cvt_pk_bf16_f32 v227, 0, v227
    v_lshlrev_b32 v64, 16, v78
    v_and_b32 v65, s40, v78
    v_lshlrev_b32 v66, 16, v79
    v_and_b32 v67, s40, v79
    v_lshlrev_b32 v68, 16, v38
    v_and_b32 v69, s40, v38
    v_lshlrev_b32 v70, 16, v39
    v_and_b32 v71, s40, v39
    v_pk_mul_f32 v[64:65], v[64:65], v[68:69]
    v_pk_mul_f32 v[66:67], v[66:67], v[70:71]
    v_cvt_pk_bf16_f32 v64, 0, v64
    v_cvt_pk_bf16_f32 v65, 0, v65
    v_cvt_pk_bf16_f32 v66, 0, v66
    v_cvt_pk_bf16_f32 v67, 0, v67
    v_pk_add_f32 v[228:229], v[228:229], v[64:65]
    v_pk_add_f32 v[230:231], v[230:231], v[66:67]
    v_cvt_pk_bf16_f32 v228, 0, v228
    v_cvt_pk_bf16_f32 v229, 0, v229
    v_cvt_pk_bf16_f32 v230, 0, v230
    v_cvt_pk_bf16_f32 v231, 0, v231
    s_branch fin_out
fin_slow:
    s_waitcnt vmcnt(0)
    ds_write_b128 v9, v[104:107] offset:16384
    ds_write_b128 v9, v[108:111] offset:17408
    ds_write_b128 v9, v[112:115] offset:24576
    ds_write_b128 v9, v[116:119] offset:25600
    ds_write_b128 v10, v[120:123] offset:16384
    ds_write_b128 v10, v[124:127] offset:17408
    ds_write_b128 v10, v[128:131] offset:24576
    ds_write_b128 v10, v[132:135] offset:25600
    ds_write_b128 v11, v[136:139] offset:16384
    ds_write_b128 v11, v[140:143] offset:17408
    ds_write_b128 v11, v[144:147] offset:24576
    ds_write_b128 v11, v[148:151] offset:25600
    s_waitcnt lgkmcnt(0)
    s_barrier
    ds_read_b128 v[168:171], v16 offset:16384
    ds_read_b128 v[172:175], v16 offset:17408
    ds_read_b128 v[176:179], v16 offset:24576
    ds_read_b128 v[180:183], v16 offset:25600
    ds_read_b128 v[184:187], v17 offset:16384
    ds_read_b128 v[188:191], v17 offset:17408
    ds_read_b128 v[192:195], v17 offset:24576
    ds_read_b128 v[196:199], v17 offset:25600
    ds_read_b128 v[200:203], v18 offset:16384
    ds_read_b128 v[204:207], v18 offset:17408
    ds_read_b128 v[208:211], v18 offset:24576
    ds_read_b128 v[212:215], v18 offset:25600
    s_waitcnt lgkmcnt(8)
    v_pk_add_f32 v[152:153], v[88:89], v[168:169]
    v_pk_add_f32 v[154:155], v[90:91], v[170:171]
    v_pk_add_f32 v[156:157], v[92:93], v[172:173]
    v_pk_add_f32 v[158:159], v[94:95], v[174:175]
    v_pk_add_f32 v[160:161], v[96:97], v[176:177]
    v_pk_add_f32 v[162:163], v[98:99], v[178:179]
    v_pk_add_f32 v[164:165], v[100:101], v[180:181]
    v_pk_add_f32 v[166:167], v[102:103], v[182:183]
    s_waitcnt lgkmcnt(0)
    v_pk_add_f32 v[184:185], v[184:185], v[200:201]
    v_pk_add_f32 v[186:187], v[186:187], v[202:203]
    v_pk_add_f32 v[188:189], v[188:189], v[204:205]
    v_pk_add_f32 v[190:191], v[190:191], v[206:207]
    v_pk_add_f32 v[192:193], v[192:193], v[208:209]
    v_pk_add_f32 v[194:195], v[194:195], v[210:211]
    v_pk_add_f32 v[196:197], v[196:197], v[212:213]
    v_pk_add_f32 v[198:199], v[198:199], v[214:215]
    v_pk_add_f32 v[152:153], v[152:153], v[184:185]
    v_pk_add_f32 v[154:155], v[154:155], v[186:187]
    v_pk_add_f32 v[156:157], v[156:157], v[188:189]
    v_pk_add_f32 v[158:159], v[158:159], v[190:191]
    v_pk_add_f32 v[160:161], v[160:161], v[192:193]
    v_pk_add_f32 v[162:163], v[162:163], v[194:195]
    v_pk_add_f32 v[164:165], v[164:165], v[196:197]
    v_pk_add_f32 v[166:167], v[166:167], v[198:199]
    v_cvt_pk_bf16_f32 v152, 0, v152
    v_cvt_pk_bf16_f32 v153, 0, v153
    v_cvt_pk_bf16_f32 v154, 0, v154
    v_cvt_pk_bf16_f32 v155, 0, v155
    v_cvt_pk_bf16_f32 v156, 0, v156
    v_cvt_pk_bf16_f32 v157, 0, v157
    v_cvt_pk_bf16_f32 v158, 0, v158
    v_cvt_pk_bf16_f32 v159, 0, v159
    v_cvt_pk_bf16_f32 v160, 0, v160
    v_cvt_pk_bf16_f32 v161, 0, v161
    v_cvt_pk_bf16_f32 v162, 0, v162
    v_cvt_pk_bf16_f32 v163, 0, v163
    v_cvt_pk_bf16_f32 v164, 0, v164
    v_cvt_pk_bf16_f32 v165, 0, v165
    v_cvt_pk_bf16_f32 v166, 0, v166
    v_cvt_pk_bf16_f32 v167, 0, v167
    s_mov_b32 exec_hi, 0
    s_mov_b32 s92, 200000
    s_lshl_b32 s93, s49, 4
poll_l9:
    buffer_load_dwordx2 v[248:249], v15, s[56:59], s93 offen sc0 sc1
    s_waitcnt vmcnt(0)
    v_cmp_ne_u64 vcc, s[90:91], v[248:249]
    s_cmp_eq_u64 vcc, 0
    s_cbranch_scc1 poll_d9
    s_mov_b64 exec, vcc
    s_sleep 2
    s_sub_u32 s92, s92, 1
    s_cmp_lg_u32 s92, 0
    s_cbranch_scc1 poll_l9
poll_d9:
    s_mov_b64 exec, -1
    s_add_u32 s38, s48, 0
    s_add_u32 m0, s37, 0
    s_nop 0
    buffer_load_dwordx4 v0, s[44:47], s38 offen lds
    s_add_u32 s38, s48, 65536
    s_add_u32 m0, s37, 1024
    s_nop 0
    buffer_load_dwordx4 v0, s[44:47], s38 offen lds
    s_waitcnt vmcnt(0)
    ds_read_b64_tr_b16 v[32:33], v14 offset:0
    ds_read_b64_tr_b16 v[34:35], v14 offset:512
    ds_read_b64_tr_b16 v[36:37], v14 offset:1024
    ds_read_b64_tr_b16 v[38:39], v14 offset:1536
    s_waitcnt lgkmcnt(0)
    v_lshlrev_b32 v216, 16, v232
    v_and_b32 v217, s40, v232
    v_lshlrev_b32 v218, 16, v233
    v_and_b32 v219, s40, v233
    v_lshlrev_b32 v64, 16, v72
    v_and_b32 v65, s40, v72
    v_lshlrev_b32 v66, 16, v73
    v_and_b32 v67, s40, v73
    v_lshlrev_b32 v68, 16, v32
    v_and_b32 v69, s40, v32
    v_lshlrev_b32 v70, 16, v33
    v_and_b32 v71, s40, v33
    v_pk_mul_f32 v[64:65], v[64:65], v[68:69]
    v_pk_mul_f32 v[66:67], v[66:67], v[70:71]
    v_cvt_pk_bf16_f32 v64, 0, v64
    v_cvt_pk_bf16_f32 v65, 0, v65
    v_cvt_pk_bf16_f32 v66, 0, v66
    v_cvt_pk_bf16_f32 v67, 0, v67
    v_pk_add_f32 v[216:217], v[216:217], v[64:65]
    v_pk_add_f32 v[218:219], v[218:219], v[66:67]
    v_cvt_pk_bf16_f32 v216, 0, v216
    v_cvt_pk_bf16_f32 v217, 0, v217
    v_cvt_pk_bf16_f32 v218, 0, v218
    v_cvt_pk_bf16_f32 v219, 0, v219
    v_lshlrev_b32 v220, 16, v234
    v_and_b32 v221, s40, v234
    v_lshlrev_b32 v222, 16, v235
    v_and_b32 v223, s40, v235
    v_lshlrev_b32 v64, 16, v74
    v_and_b32 v65, s40, v74
    v_lshlrev_b32 v66, 16, v75
    v_and_b32 v67, s40, v75
    v_lshlrev_b32 v68, 16, v34
    v_and_b32 v69, s40, v34
    v_lshlrev_b32 v70, 16, v35
    v_and_b32 v71, s40, v35
    v_pk_mul_f32 v[64:65], v[64:65], v[68:69]
    v_pk_mul_f32 v[66:67], v[66:67], v[70:71]
    v_cvt_pk_bf16_f32 v64, 0, v64
    v_cvt_pk_bf16_f32 v65, 0, v65
    v_cvt_pk_bf16_f32 v66, 0, v66
    v_cvt_pk_bf16_f32 v67, 0, v67
    v_pk_add_f32 v[220:221], v[220:221], v[64:65]
    v_pk_add_f32 v[222:223], v[222:223], v[66:67]
    v_cvt_pk_bf16_f32 v220, 0, v220
    v_cvt_pk_bf16_f32 v221, 0, v221
    v_cvt_pk_bf16_f32 v222, 0, v222
    v_cvt_pk_bf16_f32 v223, 0, v223
    v_lshlrev_b32 v224, 16, v236
    v_and_b32 v225, s40, v236
    v_lshlrev_b32 v226, 16, v237
    v_and_b32 v227, s40, v237
    v_lshlrev_b32 v64, 16, v76
    v_and_b32 v65, s40, v76
    v_lshlrev_b32 v66, 16, v77
    v_and_b32 v67, s40, v77
    v_lshlrev_b32 v68, 16, v36
    v_and_b32 v69, s40, v36
    v_lshlrev_b32 v70, 16, v37
    v_and_b32 v71, s40, v37
    v_pk_mul_f32 v[64:65], v[64:65], v[68:69]
    v_pk_mul_f32 v[66:67], v[66:67], v[70:71]
    v_cvt_pk_bf16_f32 v64, 0, v64
    v_cvt_pk_bf16_f32 v65, 0, v65
    v_cvt_pk_bf16_f32 v66, 0, v66
    v_cvt_pk_bf16_f32 v67, 0, v67
    v_pk_add_f32 v[224:225], v[224:225], v[64:65]
    v_pk_add_f32 v[226:227], v[226:227], v[66:67]
    v_cvt_pk_bf16_f32 v224, 0, v224
    v_cvt_pk_bf16_f32 v225, 0, v225
    v_cvt_pk_bf16_f32 v226, 0, v226
    v_cvt_pk_bf16_f32 v227, 0, v227
    v_lshlrev_b32 v228, 16, v238
    v_and_b32 v229, s40, v238
    v_lshlrev_b32 v230, 16, v239
    v_and_b32 v231, s40, v239
    v_lshlrev_b32 v64, 16, v78
    v_and_b32 v65, s40, v78
    v_lshlrev_b32 v66, 16, v79
    v_and_b32 v67, s40, v79
    v_lshlrev_b32 v68, 16, v38
    v_and_b32 v69, s40, v38
    v_lshlrev_b32 v70, 16, v39
    v_and_b32 v71, s40, v39
    v_pk_mul_f32 v[64:65], v[64:65], v[68:69]
    v_pk_mul_f32 v[66:67], v[66:67], v[70:71]
    v_cvt_pk_bf16_f32 v64, 0, v64
    v_cvt_pk_bf16_f32 v65, 0, v65
    v_cvt_pk_bf16_f32 v66, 0, v66
    v_cvt_pk_bf16_f32 v67, 0, v67
    v_pk_add_f32 v[228:229], v[228:229], v[64:65]
    v_pk_add_f32 v[230:231], v[230:231], v[66:67]
    v_cvt_pk_bf16_f32 v228, 0, v228
    v_cvt_pk_bf16_f32 v229, 0, v229
    v_cvt_pk_bf16_f32 v230, 0, v230
    v_cvt_pk_bf16_f32 v231, 0, v231
fin_out:
    v_pk_add_f32 v[216:217], v[216:217], v[152:153]
    v_pk_add_f32 v[218:219], v[218:219], v[154:155]
    v_cvt_pk_bf16_f32 v64, v216, v217
    v_cvt_pk_bf16_f32 v65, v218, v219
    buffer_store_dwordx2 v[64:65], v23, s[52:55], 0 offen offset:0
    v_pk_add_f32 v[220:221], v[220:221], v[156:157]
    v_pk_add_f32 v[222:223], v[222:223], v[158:159]
    v_cvt_pk_bf16_f32 v66, v220, v221
    v_cvt_pk_bf16_f32 v67, v222, v223
    buffer_store_dwordx2 v[66:67], v23, s[52:55], 0 offen offset:16
    v_pk_add_f32 v[224:225], v[224:225], v[160:161]
    v_pk_add_f32 v[226:227], v[226:227], v[162:163]
    v_cvt_pk_bf16_f32 v68, v224, v225
    v_cvt_pk_bf16_f32 v69, v226, v227
    buffer_store_dwordx2 v[68:69], v23, s[52:55], 0 offen offset:32
    v_pk_add_f32 v[228:229], v[228:229], v[164:165]
    v_pk_add_f32 v[230:231], v[230:231], v[166:167]
    v_cvt_pk_bf16_f32 v70, v228, v229
    v_cvt_pk_bf16_f32 v71, v230, v231
    buffer_store_dwordx2 v[70:71], v23, s[52:55], 0 offen offset:48
    s_endpgm
c_type:
    s_setprio 1
    s_sub_u32 s2, s2, 256
    s_mov_b32 s16, s66
    s_and_b32 s17, s67, 0xffff
    s_mov_b32 s18, 2097152
    s_mov_b32 s19, 0x00020000
    s_mov_b32 s20, s68
    s_and_b32 s21, s69, 0xffff
    s_mov_b32 s22, 2097152
    s_mov_b32 s23, 0x00020000
    s_mov_b32 s24, s70
    s_and_b32 s25, s71, 0xffff
    s_mov_b32 s26, 4096
    s_mov_b32 s27, 0x00020000
    s_lshr_b32 s32, s2, 3
    s_and_b32 s33, s2, 7
    v_and_b32 v10, 31, v0
    v_lshrrev_b32 v11, 5, v0
    s_lshl_b32 s34, s32, 6
    v_lshlrev_b32 v3, 3, v11
    v_add_u32 v3, s34, v3
    s_lshl_b32 s35, s33, 5
    v_add_u32 v6, s35, v10
    v_lshlrev_b32 v3, 10, v3
    v_lshl_add_u32 v3, v6, 2, v3
    v_add_u32 v4, 4096, v3
    v_subrev_u32 v5, 3072, v3
    v_lshlrev_b32 v6, 4, v6
    buffer_load_dword v132, v5, s[16:19], 0 offen offset:0
    buffer_load_dword v133, v5, s[16:19], 0 offen offset:1024
    buffer_load_dword v134, v5, s[16:19], 0 offen offset:2048
    buffer_load_dword v135, v3, s[16:19], 0 offen offset:0
    buffer_load_dword v136, v3, s[16:19], 0 offen offset:1024
    buffer_load_dword v137, v3, s[16:19], 0 offen offset:2048
    buffer_load_dword v138, v3, s[16:19], 0 offen offset:3072
    buffer_load_dword v139, v4, s[16:19], 0 offen offset:0
    buffer_load_dword v140, v4, s[16:19], 0 offen offset:1024
    buffer_load_dword v141, v4, s[16:19], 0 offen offset:2048
    buffer_load_dword v142, v4, s[16:19], 0 offen offset:3072
    buffer_load_dword v144, v3, s[20:23], 0 offen offset:0
    buffer_load_dword v145, v3, s[20:23], 0 offen offset:1024
    buffer_load_dword v146, v3, s[20:23], 0 offen offset:2048
    buffer_load_dword v147, v3, s[20:23], 0 offen offset:3072
    buffer_load_dword v148, v4, s[20:23], 0 offen offset:0
    buffer_load_dword v149, v4, s[20:23], 0 offen offset:1024
    buffer_load_dword v150, v4, s[20:23], 0 offen offset:2048
    buffer_load_dword v151, v4, s[20:23], 0 offen offset:3072
    buffer_load_dwordx4 v[128:131], v6, s[24:27], 0 offen
    s_lshr_b32 s31, s3, 1
    s_lshl_b32 s30, s33, 6
    s_lshl_b32 s34, s32, 1
    s_add_u32 s30, s30, s34
    s_add_u32 s30, s30, s31
    s_mov_b32 s50, s32
    s_mov_b32 s51, s33
    s_and_b32 s32, s3, 1
    s_lshl_b32 s33, s30, 12
    s_add_u32 s44, s72, s33
    s_addc_u32 s45, s73, 0
    s_and_b32 s45, s45, 0xffff
    s_mov_b32 s46, 4096
    s_mov_b32 s47, 0x00020000
    s_mul_i32 s35, s31, 39424
    s_lshl_b32 s36, s32, 6
    v_add_u32 v3, s36, v1
    v_lshlrev_b32 v4, 4, v3
    v_subrev_u32 v5, 8, v4
    v_add_u32 v29, 2040, v4
    s_add_u32 s44, s72, s33
    s_addc_u32 s45, s73, 0
    s_and_b32 s45, s45, 0xffff
    s_mov_b32 s46, 4096
    s_mov_b32 s47, 0x00020000
    buffer_load_dwordx4 v[18:21], v4, s[44:47], 0 offen
    buffer_load_dwordx4 v[24:27], v4, s[44:47], 0 offen offset:2048
    buffer_load_dwordx2 v[16:17], v5, s[44:47], 0 offen
    buffer_load_dwordx2 v[22:23], v29, s[44:47], 0 offen
    s_mov_b32 s44, s74
    s_and_b32 s45, s75, 0xffff
    s_mov_b32 s46, 1024
    s_mov_b32 s47, 0x00020000
    s_lshl_b32 s36, s30, 1
    v_mov_b32 v7, s36
    buffer_load_ushort v9, v7, s[44:47], 0 offen
    s_add_u32 s8, s88, 2097152
    s_addc_u32 s9, s89, 0
    s_and_b32 s9, s9, 0xffff
    s_mov_b32 s10, 2097152
    s_mov_b32 s11, 0x00020000
    s_add_u32 s12, s88, 14680064
    s_addc_u32 s13, s89, 0
    s_and_b32 s13, s13, 0xffff
    s_mov_b32 s14, 2097152
    s_mov_b32 s15, 0x00020000
    s_getreg_b32 s6, hwreg(HW_REG_XCC_ID, 0, 4)
    v_lshrrev_b32 v12, 4, v10
    v_mul_u32_u24 v12, 39424, v12
    v_and_b32 v13, 15, v10
    v_lshl_add_u32 v12, v13, 8, v12
    v_sub_u32 v13, 7, v11
    v_and_b32 v14, 7, v10
    v_xor_b32 v13, v13, v14
    v_lshl_add_u32 v12, v13, 4, v12
    v_add_u32 v12, 5376, v12
    v_lshrrev_b32 v13, 3, v1
    v_and_b32 v14, 7, v1
    v_lshrrev_b32 v15, 4, v1
    v_xor_b32 v15, v15, v14
    v_lshlrev_b32 v15, 4, v15
    v_lshl_add_u32 v15, v13, 7, v15
    s_mul_i32 s36, s31, 39424
    s_lshl_b32 s37, s32, 11
    s_add_u32 s36, s36, s37
    s_add_u32 s36, s36, 5376
    v_add_u32 v15, s36, v15
    v_xor_b32 v28, 64, v15
    v_lshlrev_b32 v13, 12, v13
    v_lshl_add_u32 v13, v14, 4, v13
    s_lshl_b32 s36, s51, 18
    s_lshl_b32 s37, s3, 16
    s_add_u32 s36, s36, s37
    s_lshl_b32 s37, s50, 7
    s_sub_u32 s37, 3968, s37
    s_add_u32 s48, s36, s37
    s_lshl_b32 s36, s51, 10
    s_add_u32 s36, s36, 8192
    s_lshl_b32 s37, s3, 8
    s_add_u32 s49, s36, s37
    s_lshl_b32 s37, s50, 3
    s_add_u32 s49, s49, s37
    s_lshr_b32 s37, s50, 3
    s_lshl_b32 s37, s37, 8
    s_add_u32 s41, s36, s37
    s_waitcnt vmcnt(5)
    buffer_load_dwordx2 v[252:253], off, s[60:63], 0
    v_lshlrev_b32 v32, 16, v128
    v_lshlrev_b32 v33, 16, v130
    v_and_b32 v34, s40, v128
    v_and_b32 v35, s40, v130
    v_lshlrev_b32 v36, 16, v129
    v_lshlrev_b32 v37, 16, v131
    v_and_b32 v38, s40, v129
    v_and_b32 v39, s40, v131
    v_lshlrev_b32 v40, 16, v132
    v_and_b32 v41, s40, v132
    v_lshlrev_b32 v42, 16, v133
    v_and_b32 v43, s40, v133
    v_lshlrev_b32 v44, 16, v134
    v_and_b32 v45, s40, v134
    v_lshlrev_b32 v46, 16, v135
    v_and_b32 v47, s40, v135
    v_lshlrev_b32 v48, 16, v136
    v_and_b32 v49, s40, v136
    v_lshlrev_b32 v50, 16, v137
    v_and_b32 v51, s40, v137
    v_lshlrev_b32 v52, 16, v138
    v_and_b32 v53, s40, v138
    v_lshlrev_b32 v54, 16, v139
    v_and_b32 v55, s40, v139
    v_lshlrev_b32 v56, 16, v140
    v_and_b32 v57, s40, v140
    v_lshlrev_b32 v58, 16, v141
    v_and_b32 v59, s40, v141
    v_lshlrev_b32 v60, 16, v142
    v_and_b32 v61, s40, v142
    v_lshlrev_b32 v64, 16, v144
    v_and_b32 v65, s40, v144
    v_lshlrev_b32 v66, 16, v145
    v_and_b32 v67, s40, v145
    v_lshlrev_b32 v68, 16, v146
    v_and_b32 v69, s40, v146
    v_lshlrev_b32 v70, 16, v147
    v_and_b32 v71, s40, v147
    v_lshlrev_b32 v72, 16, v148
    v_and_b32 v73, s40, v148
    v_lshlrev_b32 v74, 16, v149
    v_and_b32 v75, s40, v149
    v_lshlrev_b32 v76, 16, v150
    v_and_b32 v77, s40, v150
    v_lshlrev_b32 v78, 16, v151
    v_and_b32 v79, s40, v151
    v_mul_f32 v96, v40, v38
    v_mul_f32 v97, v41, v39
    v_mul_f32 v98, v42, v36
    v_mul_f32 v99, v43, v37
    v_mul_f32 v100, v44, v34
    v_mul_f32 v101, v45, v35
    v_mul_f32 v102, v46, v32
    v_mul_f32 v103, v47, v33
    v_cvt_pk_bf16_f32 v96, 0, v96
    v_cvt_pk_bf16_f32 v97, 0, v97
    v_cvt_pk_bf16_f32 v98, 0, v98
    v_cvt_pk_bf16_f32 v99, 0, v99
    v_cvt_pk_bf16_f32 v100, 0, v100
    v_cvt_pk_bf16_f32 v101, 0, v101
    v_cvt_pk_bf16_f32 v102, 0, v102
    v_cvt_pk_bf16_f32 v103, 0, v103
    v_add_f32 v96, v96, v98
    v_add_f32 v97, v97, v99
    v_cvt_pk_bf16_f32 v96, 0, v96
    v_cvt_pk_bf16_f32 v97, 0, v97
    v_add_f32 v96, v96, v100
    v_add_f32 v97, v97, v101
    v_cvt_pk_bf16_f32 v96, 0, v96
    v_cvt_pk_bf16_f32 v97, 0, v97
    v_add_f32 v96, v96, v102
    v_add_f32 v97, v97, v103
    v_cvt_pk_bf16_f32 v96, 0, v96
    v_cvt_pk_bf16_f32 v97, 0, v97
    v_mul_f32 v80, v96, v64
    v_mul_f32 v81, v97, v65
    v_mul_f32 v104, v42, v38
    v_mul_f32 v105, v43, v39
    v_mul_f32 v106, v44, v36
    v_mul_f32 v107, v45, v37
    v_mul_f32 v108, v46, v34
    v_mul_f32 v109, v47, v35
    v_mul_f32 v110, v48, v32
    v_mul_f32 v111, v49, v33
    v_cvt_pk_bf16_f32 v104, 0, v104
    v_cvt_pk_bf16_f32 v105, 0, v105
    v_cvt_pk_bf16_f32 v106, 0, v106
    v_cvt_pk_bf16_f32 v107, 0, v107
    v_cvt_pk_bf16_f32 v108, 0, v108
    v_cvt_pk_bf16_f32 v109, 0, v109
    v_cvt_pk_bf16_f32 v110, 0, v110
    v_cvt_pk_bf16_f32 v111, 0, v111
    v_add_f32 v104, v104, v106
    v_add_f32 v105, v105, v107
    v_cvt_pk_bf16_f32 v104, 0, v104
    v_cvt_pk_bf16_f32 v105, 0, v105
    v_add_f32 v104, v104, v108
    v_add_f32 v105, v105, v109
    v_cvt_pk_bf16_f32 v104, 0, v104
    v_cvt_pk_bf16_f32 v105, 0, v105
    v_add_f32 v104, v104, v110
    v_add_f32 v105, v105, v111
    v_cvt_pk_bf16_f32 v104, 0, v104
    v_cvt_pk_bf16_f32 v105, 0, v105
    v_mul_f32 v82, v104, v66
    v_mul_f32 v83, v105, v67
    v_mul_f32 v96, v44, v38
    v_mul_f32 v97, v45, v39
    v_mul_f32 v98, v46, v36
    v_mul_f32 v99, v47, v37
    v_mul_f32 v100, v48, v34
    v_mul_f32 v101, v49, v35
    v_mul_f32 v102, v50, v32
    v_mul_f32 v103, v51, v33
    v_cvt_pk_bf16_f32 v96, 0, v96
    v_cvt_pk_bf16_f32 v97, 0, v97
    v_cvt_pk_bf16_f32 v98, 0, v98
    v_cvt_pk_bf16_f32 v99, 0, v99
    v_cvt_pk_bf16_f32 v100, 0, v100
    v_cvt_pk_bf16_f32 v101, 0, v101
    v_cvt_pk_bf16_f32 v102, 0, v102
    v_cvt_pk_bf16_f32 v103, 0, v103
    v_add_f32 v96, v96, v98
    v_add_f32 v97, v97, v99
    v_cvt_pk_bf16_f32 v96, 0, v96
    v_cvt_pk_bf16_f32 v97, 0, v97
    v_add_f32 v96, v96, v100
    v_add_f32 v97, v97, v101
    v_cvt_pk_bf16_f32 v96, 0, v96
    v_cvt_pk_bf16_f32 v97, 0, v97
    v_add_f32 v96, v96, v102
    v_add_f32 v97, v97, v103
    v_cvt_pk_bf16_f32 v96, 0, v96
    v_cvt_pk_bf16_f32 v97, 0, v97
    v_mul_f32 v84, v96, v68
    v_mul_f32 v85, v97, v69
    v_mul_f32 v104, v46, v38
    v_mul_f32 v105, v47, v39
    v_mul_f32 v106, v48, v36
    v_mul_f32 v107, v49, v37
    v_mul_f32 v108, v50, v34
    v_mul_f32 v109, v51, v35
    v_mul_f32 v110, v52, v32
    v_mul_f32 v111, v53, v33
    v_cvt_pk_bf16_f32 v104, 0, v104
    v_cvt_pk_bf16_f32 v105, 0, v105
    v_cvt_pk_bf16_f32 v106, 0, v106
    v_cvt_pk_bf16_f32 v107, 0, v107
    v_cvt_pk_bf16_f32 v108, 0, v108
    v_cvt_pk_bf16_f32 v109, 0, v109
    v_cvt_pk_bf16_f32 v110, 0, v110
    v_cvt_pk_bf16_f32 v111, 0, v111
    v_add_f32 v104, v104, v106
    v_add_f32 v105, v105, v107
    v_cvt_pk_bf16_f32 v104, 0, v104
    v_cvt_pk_bf16_f32 v105, 0, v105
    v_add_f32 v104, v104, v108
    v_add_f32 v105, v105, v109
    v_cvt_pk_bf16_f32 v104, 0, v104
    v_cvt_pk_bf16_f32 v105, 0, v105
    v_add_f32 v104, v104, v110
    v_add_f32 v105, v105, v111
    v_cvt_pk_bf16_f32 v104, 0, v104
    v_cvt_pk_bf16_f32 v105, 0, v105
    v_mul_f32 v86, v104, v70
    v_mul_f32 v87, v105, v71
    v_mul_f32 v96, v48, v38
    v_mul_f32 v97, v49, v39
    v_mul_f32 v98, v50, v36
    v_mul_f32 v99, v51, v37
    v_mul_f32 v100, v52, v34
    v_mul_f32 v101, v53, v35
    v_mul_f32 v102, v54, v32
    v_mul_f32 v103, v55, v33
    v_cvt_pk_bf16_f32 v96, 0, v96
    v_cvt_pk_bf16_f32 v97, 0, v97
    v_cvt_pk_bf16_f32 v98, 0, v98
    v_cvt_pk_bf16_f32 v99, 0, v99
    v_cvt_pk_bf16_f32 v100, 0, v100
    v_cvt_pk_bf16_f32 v101, 0, v101
    v_cvt_pk_bf16_f32 v102, 0, v102
    v_cvt_pk_bf16_f32 v103, 0, v103
    v_add_f32 v96, v96, v98
    v_add_f32 v97, v97, v99
    v_cvt_pk_bf16_f32 v96, 0, v96
    v_cvt_pk_bf16_f32 v97, 0, v97
    v_add_f32 v96, v96, v100
    v_add_f32 v97, v97, v101
    v_cvt_pk_bf16_f32 v96, 0, v96
    v_cvt_pk_bf16_f32 v97, 0, v97
    v_add_f32 v96, v96, v102
    v_add_f32 v97, v97, v103
    v_cvt_pk_bf16_f32 v96, 0, v96
    v_cvt_pk_bf16_f32 v97, 0, v97
    v_mul_f32 v88, v96, v72
    v_mul_f32 v89, v97, v73
    v_mul_f32 v104, v50, v38
    v_mul_f32 v105, v51, v39
    v_mul_f32 v106, v52, v36
    v_mul_f32 v107, v53, v37
    v_mul_f32 v108, v54, v34
    v_mul_f32 v109, v55, v35
    v_mul_f32 v110, v56, v32
    v_mul_f32 v111, v57, v33
    v_cvt_pk_bf16_f32 v104, 0, v104
    v_cvt_pk_bf16_f32 v105, 0, v105
    v_cvt_pk_bf16_f32 v106, 0, v106
    v_cvt_pk_bf16_f32 v107, 0, v107
    v_cvt_pk_bf16_f32 v108, 0, v108
    v_cvt_pk_bf16_f32 v109, 0, v109
    v_cvt_pk_bf16_f32 v110, 0, v110
    v_cvt_pk_bf16_f32 v111, 0, v111
    v_add_f32 v104, v104, v106
    v_add_f32 v105, v105, v107
    v_cvt_pk_bf16_f32 v104, 0, v104
    v_cvt_pk_bf16_f32 v105, 0, v105
    v_add_f32 v104, v104, v108
    v_add_f32 v105, v105, v109
    v_cvt_pk_bf16_f32 v104, 0, v104
    v_cvt_pk_bf16_f32 v105, 0, v105
    v_add_f32 v104, v104, v110
    v_add_f32 v105, v105, v111
    v_cvt_pk_bf16_f32 v104, 0, v104
    v_cvt_pk_bf16_f32 v105, 0, v105
    v_mul_f32 v90, v104, v74
    v_mul_f32 v91, v105, v75
    v_mul_f32 v96, v52, v38
    v_mul_f32 v97, v53, v39
    v_mul_f32 v98, v54, v36
    v_mul_f32 v99, v55, v37
    v_mul_f32 v100, v56, v34
    v_mul_f32 v101, v57, v35
    v_mul_f32 v102, v58, v32
    v_mul_f32 v103, v59, v33
    v_cvt_pk_bf16_f32 v96, 0, v96
    v_cvt_pk_bf16_f32 v97, 0, v97
    v_cvt_pk_bf16_f32 v98, 0, v98
    v_cvt_pk_bf16_f32 v99, 0, v99
    v_cvt_pk_bf16_f32 v100, 0, v100
    v_cvt_pk_bf16_f32 v101, 0, v101
    v_cvt_pk_bf16_f32 v102, 0, v102
    v_cvt_pk_bf16_f32 v103, 0, v103
    v_add_f32 v96, v96, v98
    v_add_f32 v97, v97, v99
    v_cvt_pk_bf16_f32 v96, 0, v96
    v_cvt_pk_bf16_f32 v97, 0, v97
    v_add_f32 v96, v96, v100
    v_add_f32 v97, v97, v101
    v_cvt_pk_bf16_f32 v96, 0, v96
    v_cvt_pk_bf16_f32 v97, 0, v97
    v_add_f32 v96, v96, v102
    v_add_f32 v97, v97, v103
    v_cvt_pk_bf16_f32 v96, 0, v96
    v_cvt_pk_bf16_f32 v97, 0, v97
    v_mul_f32 v92, v96, v76
    v_mul_f32 v93, v97, v77
    v_mul_f32 v104, v54, v38
    v_mul_f32 v105, v55, v39
    v_mul_f32 v106, v56, v36
    v_mul_f32 v107, v57, v37
    v_mul_f32 v108, v58, v34
    v_mul_f32 v109, v59, v35
    v_mul_f32 v110, v60, v32
    v_mul_f32 v111, v61, v33
    v_cvt_pk_bf16_f32 v104, 0, v104
    v_cvt_pk_bf16_f32 v105, 0, v105
    v_cvt_pk_bf16_f32 v106, 0, v106
    v_cvt_pk_bf16_f32 v107, 0, v107
    v_cvt_pk_bf16_f32 v108, 0, v108
    v_cvt_pk_bf16_f32 v109, 0, v109
    v_cvt_pk_bf16_f32 v110, 0, v110
    v_cvt_pk_bf16_f32 v111, 0, v111
    v_add_f32 v104, v104, v106
    v_add_f32 v105, v105, v107
    v_cvt_pk_bf16_f32 v104, 0, v104
    v_cvt_pk_bf16_f32 v105, 0, v105
    v_add_f32 v104, v104, v108
    v_add_f32 v105, v105, v109
    v_cvt_pk_bf16_f32 v104, 0, v104
    v_cvt_pk_bf16_f32 v105, 0, v105
    v_add_f32 v104, v104, v110
    v_add_f32 v105, v105, v111
    v_cvt_pk_bf16_f32 v104, 0, v104
    v_cvt_pk_bf16_f32 v105, 0, v105
    v_mul_f32 v94, v104, v78
    v_mul_f32 v95, v105, v79
    v_cvt_pk_bf16_f32 v104, v94, v92
    v_cvt_pk_bf16_f32 v105, v90, v88
    v_cvt_pk_bf16_f32 v106, v86, v84
    v_cvt_pk_bf16_f32 v107, v82, v80
    v_cvt_pk_bf16_f32 v108, v95, v93
    v_cvt_pk_bf16_f32 v109, v91, v89
    v_cvt_pk_bf16_f32 v110, v87, v85
    v_cvt_pk_bf16_f32 v111, v83, v81
    ds_write_b128 v12, v[104:107]
    ds_write_b128 v12, v[108:111] offset:128
    s_waitcnt lgkmcnt(0)
    s_barrier
    ds_read_b128 v[104:107], v15
    ds_read_b128 v[108:111], v28 offset:1024
    s_add_u32 s43, s48, 32768
    s_waitcnt lgkmcnt(1)
    buffer_store_dwordx4 v[104:107], v13, s[12:15], s48 offen
    s_waitcnt lgkmcnt(0)
    buffer_store_dwordx4 v[108:111], v13, s[12:15], s43 offen
    s_add_u32 s34, s33, 2097152
    s_add_u32 s20, s88, s34
    s_addc_u32 s21, s89, 0
    s_and_b32 s21, s21, 0xffff
    s_mov_b32 s22, 4096
    s_mov_b32 s23, 0x00020000
    s_add_u32 s34, s33, 10485760
    s_add_u32 s24, s88, s34
    s_addc_u32 s25, s89, 0
    s_and_b32 s25, s25, 0xffff
    s_mov_b32 s26, 4096
    s_mov_b32 s27, 0x00020000
    v_mov_b32 v36, 0
    v_mov_b32 v37, 0
    v_mov_b32 v38, 0
    v_mov_b32 v39, 0
    v_mul_u32_u24 v7, 37, v1
    v_lshrrev_b32 v7, 8, v7
    v_mul_u32_u24 v7, 4304, v7
    v_lshl_add_u32 v7, v1, 4, v7
    v_add_u32 v7, s35, v7
    s_mov_b32 exec_hi, 7
    ds_write_b128 v7, v[36:39] offset:5120
    s_mov_b64 exec, -1
    v_lshlrev_b32 v6, 4, v3
    v_add_u32 v7, s35, v6
    v_lshrrev_b32 v8, 2, v3
    v_mul_u32_u24 v8, 80, v8
    v_and_b32 v10, 3, v3
    v_lshl_add_u32 v8, v10, 4, v8
    v_add_u32 v8, s35, v8
    v_and_b32 v3, 31, v1
    v_lshrrev_b32 v4, 5, v1
    v_and_b32 v14, 3, v3
    v_mul_u32_u24 v10, 4414, v14
    v_lshl_add_u32 v10, v3, 1, v10
    v_lshlrev_b32 v14, 4, v4
    v_sub_u32 v10, v10, v14
    s_add_u32 s36, s35, 9544
    v_add_u32 v10, s36, v10
    v_sub_u32 v5, 63, v3
    v_mul_u32_u24 v5, 80, v5
    v_lshlrev_b32 v14, 4, v4
    v_sub_u32 v5, v5, v14
    s_add_u32 s36, s35, 16
    v_add_u32 v11, s36, v5
    v_subrev_u32 v15, 2560, v11
    s_add_u32 s36, s36, 5120
    v_sub_u32 v12, s36, v14
    v_lshlrev_b32 v14, 3, v4
    v_add_u32 v5, v5, v14
    s_mul_i32 s36, s32, 2560
    s_sub_u32 s36, 8, s36
    s_add_u32 s36, s36, s35
    v_add_u32 v5, s36, v5
    s_lshl_b32 s36, s32, 10
    v_add_u32 v10, s36, v10
    s_mul_i32 s36, s32, 1280
    v_add_u32 v11, s36, v11
    v_add_u32 v15, s36, v15
    v_add_u32 v14, 2048, v10
    s_waitcnt vmcnt(2)
    s_mov_b32 s92, 200000
tok_l10:
    v_readfirstlane_b32 s90, v252
    v_readfirstlane_b32 s91, v253
    s_cmp_lg_u32 s90, 0
    s_cbranch_scc1 tok_d10
    buffer_load_dwordx2 v[252:253], off, s[60:63], 0 sc0 sc1
    s_waitcnt vmcnt(0)
    s_sub_u32 s92, s92, 1
    s_cmp_lg_u32 s92, 0
    s_cbranch_scc1 tok_l10
tok_d10:
    s_add_u32 s6, s6, 1
    s_lshl_b32 s6, s6, 24
    s_mov_b32 s4, s90
    s_xor_b32 s5, s91, s6
    v_mov_b32 v244, s4
    v_mov_b32 v245, s5
    s_sub_u32 s93, s49, 8192
    s_lshl_b32 s93, s93, 4
    s_waitcnt vmcnt(0)
    s_mov_b64 exec, 1
    buffer_store_dwordx2 v[244:245], off, s[56:59], s93
    s_mov_b64 exec, -1
    v_alignbyte_b32 v40, v17, v16, 2
    v_alignbyte_b32 v41, v18, v17, 2
    v_alignbyte_b32 v42, v19, v18, 2
    v_alignbyte_b32 v43, v20, v19, 2
    ds_write_b128 v7, v[40:43] offset:9648
    v_mov_b32 v44, v17
    v_mov_b32 v45, v18
    v_mov_b32 v46, v19
    v_mov_b32 v47, v20
    ds_write_b128 v7, v[44:47] offset:14064
    v_alignbyte_b32 v48, v18, v17, 2
    v_alignbyte_b32 v49, v19, v18, 2
    v_alignbyte_b32 v50, v20, v19, 2
    v_alignbyte_b32 v51, v21, v20, 2
    ds_write_b128 v7, v[48:51] offset:18480
    ds_write_b128 v7, v[18:21] offset:22896
    v_alignbyte_b32 v40, v23, v22, 2
    v_alignbyte_b32 v41, v24, v23, 2
    v_alignbyte_b32 v42, v25, v24, 2
    v_alignbyte_b32 v43, v26, v25, 2
    ds_write_b128 v7, v[40:43] offset:11696
    v_mov_b32 v44, v23
    v_mov_b32 v45, v24
    v_mov_b32 v46, v25
    v_mov_b32 v47, v26
    ds_write_b128 v7, v[44:47] offset:16112
    v_alignbyte_b32 v48, v24, v23, 2
    v_alignbyte_b32 v49, v25, v24, 2
    v_alignbyte_b32 v50, v26, v25, 2
    v_alignbyte_b32 v51, v27, v26, 2
    ds_write_b128 v7, v[48:51] offset:20528
    ds_write_b128 v7, v[24:27] offset:24944
    s_setprio 1
    s_mov_b32 s92, 200000
    s_mov_b32 s28, 0
    s_sub_u32 s46, s41, 8192
    s_lshl_b32 s46, s46, 4
    s_lshl_b32 s47, s41, 4
    v_mov_b32 v52, 27136
    s_cmp_lg_u32 s3, 0
    s_cbranch_scc1 p1_bar
    s_mov_b32 exec_hi, 0
    s_mov_b32 s93, 12
p1_l:
    buffer_load_dwordx2 v[248:249], v247, s[56:59], s46 offen sc0 sc1
    s_waitcnt vmcnt(0)
    v_cmp_ne_u64 vcc, s[4:5], v[248:249]
    s_cmp_eq_u64 vcc, 0
    s_cbranch_scc1 p1_ok
    s_mov_b64 exec, vcc
    s_sleep 2
    s_sub_u32 s93, s93, 1
    s_cmp_lg_u32 s93, 0
    s_cbranch_scc1 p1_l
p1_ok:
    s_mov_b64 exec, -1
    v_mov_b32 v53, s93
    ds_write_b32 v52, v53
    s_waitcnt lgkmcnt(0)
p1_bar:
    s_barrier
    ds_read_b32 v53, v52
    s_waitcnt lgkmcnt(0)
    v_readfirstlane_b32 s93, v53
    s_cmp_lg_u32 s93, 0
    s_cbranch_scc1 pk_fast
    s_mov_b32 exec_hi, 0
pk_l:
    buffer_load_dwordx2 v[248:249], v247, s[56:59], s46 offen sc0 sc1
    s_waitcnt vmcnt(0)
    v_cmp_ne_u64 vcc, s[4:5], v[248:249]
    s_cmp_eq_u64 vcc, 0
    s_cbranch_scc1 pk_fast
    s_cmp_gt_u32 s92, 199999
    s_cbranch_scc1 pk_next
    s_cmp_lg_u32 s28, 0
    s_cbranch_scc1 pk_sb
    s_mov_b64 exec, -1
    buffer_store_dwordx4 v[104:107], v13, s[8:11], s48 offen sc0 sc1
    buffer_store_dwordx4 v[108:111], v13, s[8:11], s43 offen sc0 sc1
    s_waitcnt vmcnt(0)
    s_lshl_b32 s93, s49, 4
    s_mov_b64 exec, 1
    buffer_store_dwordx2 v[252:253], off, s[56:59], s93 sc0 sc1
    s_mov_b64 exec, -1
    s_mov_b32 s28, 1
    s_mov_b32 exec_hi, 0
pk_sb:
    buffer_load_dwordx2 v[248:249], v247, s[56:59], s47 offen sc0 sc1
    s_waitcnt vmcnt(0)
    v_cmp_ne_u64 vcc, s[90:91], v[248:249]
    s_cmp_eq_u64 vcc, 0
    s_cbranch_scc1 pk_join
pk_next:
    s_sleep 2
    s_sub_u32 s92, s92, 1
    s_cmp_lg_u32 s92, 0
    s_cbranch_scc1 pk_l
    s_branch pk_join
pk_fast:
    s_add_u32 s20, s20, 12582912
    s_addc_u32 s21, s21, 0
    s_and_b32 s21, s21, 0xffff
pk_join:
    s_mov_b64 exec, -1
    buffer_load_dwordx4 v[28:31], v6, s[20:23], 0 offen
    buffer_load_dwordx4 v[32:35], v6, s[20:23], 0 offen offset:2048
    v_mov_b32 v246, v13
    s_waitcnt vmcnt(1)
    ds_write_b128 v8, v[28:31] offset:0
    s_waitcnt vmcnt(0)
    ds_write_b128 v8, v[32:35] offset:2560
    s_waitcnt lgkmcnt(0)
    s_barrier
    ds_read_b64 v[16:17], v5 offset:48
    ds_read_b64 v[18:19], v5 offset:32
    ds_read_b64 v[20:21], v5 offset:16
    ds_read_b64 v[22:23], v5 offset:0
    ds_read2_b64 v[88:91], v10 offset0:4 offset1:5
    ds_read2_b64 v[92:95], v14 offset0:4 offset1:5
    ds_read2_b64 v[64:67], v10 offset0:12 offset1:13
    ds_read_b128 v[104:107], v15 offset:32
    v_add_u32 v13, 0, v11
    v_min_u32 v13, v13, v12
    ds_read_b128 v[96:99], v13 offset:32
    ds_read_b128 v[108:111], v15 offset:0
    ds_read2_b64 v[68:71], v14 offset0:12 offset1:13
    ds_read_b128 v[100:103], v13 offset:0
    ds_read2_b64 v[72:75], v10 offset0:20 offset1:21
    ds_read_b128 v[120:123], v15 offset:112
    v_add_u32 v13, 80, v11
    v_min_u32 v13, v13, v12
    ds_read_b128 v[112:115], v13 offset:32
    ds_read_b128 v[124:127], v15 offset:80
    ds_read2_b64 v[76:79], v14 offset0:20 offset1:21
    ds_read_b128 v[116:119], v13 offset:0
    s_waitcnt lgkmcnt(6)
    v_mfma_f32_32x32x16_bf16 v[176:191], v[64:67], v[104:107], 0
    v_mov_b32_dpp v88, v64 quad_perm:[0,1,2,3] row_mask:0x5 bank_mask:0xf
    v_mov_b32_dpp v89, v65 quad_perm:[0,1,2,3] row_mask:0x5 bank_mask:0xf
    v_mov_b32_dpp v90, v66 quad_perm:[0,1,2,3] row_mask:0x5 bank_mask:0xf
    v_mov_b32_dpp v91, v67 quad_perm:[0,1,2,3] row_mask:0x5 bank_mask:0xf
    ds_read2_b64 v[80:83], v10 offset0:28 offset1:29
    v_mfma_f32_32x32x16_bf16 v[144:159], v[64:67], v[96:99], 0
    v_mov_b32_dpp v92, v68 quad_perm:[0,1,2,3] row_mask:0x5 bank_mask:0xf
    v_mov_b32_dpp v93, v69 quad_perm:[0,1,2,3] row_mask:0x5 bank_mask:0xf
    v_mov_b32_dpp v94, v70 quad_perm:[0,1,2,3] row_mask:0x5 bank_mask:0xf
    v_mov_b32_dpp v95, v71 quad_perm:[0,1,2,3] row_mask:0x5 bank_mask:0xf
    ds_read_b128 v[136:139], v15 offset:192
    v_mfma_f32_32x32x16_bf16 v[192:207], v[88:91], v[108:111], 0
    v_add_u32 v13, 160, v11
    v_min_u32 v13, v13, v12
    ds_read_b128 v[128:131], v13 offset:32
    v_mfma_f32_32x32x16_bf16 v[176:191], v[68:71], v[96:99], v[176:191]
    ds_read_b128 v[140:143], v15 offset:160
    v_mfma_f32_32x32x16_bf16 v[160:175], v[88:91], v[100:103], 0
    ds_read2_b64 v[84:87], v14 offset0:28 offset1:29
    v_mfma_f32_32x32x16_bf16 v[192:207], v[92:95], v[100:103], v[192:207]
    ds_read_b128 v[132:135], v13 offset:0
    s_waitcnt lgkmcnt(6)
    v_mfma_f32_32x32x16_bf16 v[176:191], v[72:75], v[120:123], v[176:191]
    v_mov_b32_dpp v64, v72 quad_perm:[0,1,2,3] row_mask:0x5 bank_mask:0xf
    v_mov_b32_dpp v65, v73 quad_perm:[0,1,2,3] row_mask:0x5 bank_mask:0xf
    v_mov_b32_dpp v66, v74 quad_perm:[0,1,2,3] row_mask:0x5 bank_mask:0xf
    v_mov_b32_dpp v67, v75 quad_perm:[0,1,2,3] row_mask:0x5 bank_mask:0xf
    ds_read2_b64 v[88:91], v10 offset0:36 offset1:37
    v_mfma_f32_32x32x16_bf16 v[144:159], v[72:75], v[112:115], v[144:159]
    v_mov_b32_dpp v68, v76 quad_perm:[0,1,2,3] row_mask:0x5 bank_mask:0xf
    v_mov_b32_dpp v69, v77 quad_perm:[0,1,2,3] row_mask:0x5 bank_mask:0xf
    v_mov_b32_dpp v70, v78 quad_perm:[0,1,2,3] row_mask:0x5 bank_mask:0xf
    v_mov_b32_dpp v71, v79 quad_perm:[0,1,2,3] row_mask:0x5 bank_mask:0xf
    ds_read_b128 v[104:107], v15 offset:272
    v_mfma_f32_32x32x16_bf16 v[192:207], v[64:67], v[124:127], v[192:207]
    v_add_u32 v13, 240, v11
    v_min_u32 v13, v13, v12
    ds_read_b128 v[96:99], v13 offset:32
    v_lshlrev_b32 v48, 16, v9
    v_and_b32 v32, s40, v17
    v_mfma_f32_32x32x16_bf16 v[176:191], v[76:79], v[112:115], v[176:191]
    ds_read_b128 v[108:111], v15 offset:240
    v_lshlrev_b32 v33, 16, v17
    v_and_b32 v34, s40, v16
    v_mfma_f32_32x32x16_bf16 v[160:175], v[64:67], v[116:119], v[160:175]
    ds_read2_b64 v[92:95], v14 offset0:36 offset1:37
    v_lshlrev_b32 v35, 16, v16
    v_mul_f32 v32, v32, v48
    v_mfma_f32_32x32x16_bf16 v[192:207], v[68:71], v[116:119], v[192:207]
    ds_read_b128 v[100:103], v13 offset:0
    v_mul_f32 v33, v33, v48
    v_mul_f32 v34, v34, v48
    s_waitcnt lgkmcnt(6)
    v_mfma_f32_32x32x16_bf16 v[176:191], v[80:83], v[136:139], v[176:191]
    v_mov_b32_dpp v72, v80 quad_perm:[0,1,2,3] row_mask:0x5 bank_mask:0xf
    v_mov_b32_dpp v73, v81 quad_perm:[0,1,2,3] row_mask:0x5 bank_mask:0xf
    v_mov_b32_dpp v74, v82 quad_perm:[0,1,2,3] row_mask:0x5 bank_mask:0xf
    v_mov_b32_dpp v75, v83 quad_perm:[0,1,2,3] row_mask:0x5 bank_mask:0xf
    ds_read2_b64 v[64:67], v10 offset0:44 offset1:45
    v_mfma_f32_32x32x16_bf16 v[144:159], v[80:83], v[128:131], v[144:159]
    v_mov_b32_dpp v76, v84 quad_perm:[0,1,2,3] row_mask:0x5 bank_mask:0xf
    v_mov_b32_dpp v77, v85 quad_perm:[0,1,2,3] row_mask:0x5 bank_mask:0xf
    v_mov_b32_dpp v78, v86 quad_perm:[0,1,2,3] row_mask:0x5 bank_mask:0xf
    v_mov_b32_dpp v79, v87 quad_perm:[0,1,2,3] row_mask:0x5 bank_mask:0xf
    ds_read_b128 v[120:123], v15 offset:352
    v_mfma_f32_32x32x16_bf16 v[192:207], v[72:75], v[140:143], v[192:207]
    v_add_u32 v13, 320, v11
    v_min_u32 v13, v13, v12
    ds_read_b128 v[112:115], v13 offset:32
    v_mul_f32 v35, v35, v48
    v_cvt_pk_bf16_f32 v32, 0, v32
    v_mfma_f32_32x32x16_bf16 v[176:191], v[84:87], v[128:131], v[176:191]
    ds_read_b128 v[124:127], v15 offset:320
    v_cvt_pk_bf16_f32 v33, 0, v33
    v_cvt_pk_bf16_f32 v34, 0, v34
    v_mfma_f32_32x32x16_bf16 v[160:175], v[72:75], v[132:135], v[160:175]
    ds_read2_b64 v[68:71], v14 offset0:44 offset1:45
    v_cvt_pk_bf16_f32 v35, 0, v35
    v_and_b32 v36, s40, v19
    v_mfma_f32_32x32x16_bf16 v[192:207], v[76:79], v[132:135], v[192:207]
    ds_read_b128 v[116:119], v13 offset:0
    v_lshlrev_b32 v37, 16, v19
    v_and_b32 v38, s40, v18
    s_waitcnt lgkmcnt(6)
    v_mfma_f32_32x32x16_bf16 v[176:191], v[88:91], v[104:107], v[176:191]
    v_mov_b32_dpp v80, v88 quad_perm:[0,1,2,3] row_mask:0x5 bank_mask:0xf
    v_mov_b32_dpp v81, v89 quad_perm:[0,1,2,3] row_mask:0x5 bank_mask:0xf
    v_mov_b32_dpp v82, v90 quad_perm:[0,1,2,3] row_mask:0x5 bank_mask:0xf
    v_mov_b32_dpp v83, v91 quad_perm:[0,1,2,3] row_mask:0x5 bank_mask:0xf
    ds_read2_b64 v[72:75], v10 offset0:52 offset1:53
    v_mfma_f32_32x32x16_bf16 v[144:159], v[88:91], v[96:99], v[144:159]
    v_mov_b32_dpp v84, v92 quad_perm:[0,1,2,3] row_mask:0x5 bank_mask:0xf
    v_mov_b32_dpp v85, v93 quad_perm:[0,1,2,3] row_mask:0x5 bank_mask:0xf
    v_mov_b32_dpp v86, v94 quad_perm:[0,1,2,3] row_mask:0x5 bank_mask:0xf
    v_mov_b32_dpp v87, v95 quad_perm:[0,1,2,3] row_mask:0x5 bank_mask:0xf
    ds_read_b128 v[136:139], v15 offset:432
    v_mfma_f32_32x32x16_bf16 v[192:207], v[80:83], v[108:111], v[192:207]
    v_add_u32 v13, 400, v11
    v_min_u32 v13, v13, v12
    ds_read_b128 v[128:131], v13 offset:32
    v_lshlrev_b32 v39, 16, v18
    v_mul_f32 v36, v36, v48
    v_mfma_f32_32x32x16_bf16 v[176:191], v[92:95], v[96:99], v[176:191]
    ds_read_b128 v[140:143], v15 offset:400
    v_mul_f32 v37, v37, v48
    v_mul_f32 v38, v38, v48
    v_mfma_f32_32x32x16_bf16 v[160:175], v[80:83], v[100:103], v[160:175]
    ds_read2_b64 v[76:79], v14 offset0:52 offset1:53
    v_mul_f32 v39, v39, v48
    v_cvt_pk_bf16_f32 v36, 0, v36
    v_mfma_f32_32x32x16_bf16 v[192:207], v[84:87], v[100:103], v[192:207]
    ds_read_b128 v[132:135], v13 offset:0
    v_cvt_pk_bf16_f32 v37, 0, v37
    v_cvt_pk_bf16_f32 v38, 0, v38
    s_waitcnt lgkmcnt(6)
    v_mfma_f32_32x32x16_bf16 v[176:191], v[64:67], v[120:123], v[176:191]
    v_mov_b32_dpp v88, v64 quad_perm:[0,1,2,3] row_mask:0x5 bank_mask:0xf
    v_mov_b32_dpp v89, v65 quad_perm:[0,1,2,3] row_mask:0x5 bank_mask:0xf
    v_mov_b32_dpp v90, v66 quad_perm:[0,1,2,3] row_mask:0x5 bank_mask:0xf
    v_mov_b32_dpp v91, v67 quad_perm:[0,1,2,3] row_mask:0x5 bank_mask:0xf
    ds_read2_b64 v[80:83], v10 offset0:60 offset1:61
    v_mfma_f32_32x32x16_bf16 v[144:159], v[64:67], v[112:115], v[144:159]
    v_mov_b32_dpp v92, v68 quad_perm:[0,1,2,3] row_mask:0x5 bank_mask:0xf
    v_mov_b32_dpp v93, v69 quad_perm:[0,1,2,3] row_mask:0x5 bank_mask:0xf
    v_mov_b32_dpp v94, v70 quad_perm:[0,1,2,3] row_mask:0x5 bank_mask:0xf
    v_mov_b32_dpp v95, v71 quad_perm:[0,1,2,3] row_mask:0x5 bank_mask:0xf
    ds_read_b128 v[104:107], v15 offset:512
    v_mfma_f32_32x32x16_bf16 v[192:207], v[88:91], v[124:127], v[192:207]
    v_add_u32 v13, 480, v11
    v_min_u32 v13, v13, v12
    ds_read_b128 v[96:99], v13 offset:32
    v_cvt_pk_bf16_f32 v39, 0, v39
    v_and_b32 v40, s40, v21
    v_mfma_f32_32x32x16_bf16 v[176:191], v[68:71], v[112:115], v[176:191]
    ds_read_b128 v[108:111], v15 offset:480
    v_lshlrev_b32 v41, 16, v21
    v_and_b32 v42, s40, v20
    v_mfma_f32_32x32x16_bf16 v[160:175], v[88:91], v[116:119], v[160:175]
    ds_read2_b64 v[84:87], v14 offset0:60 offset1:61
    v_lshlrev_b32 v43, 16, v20
    v_mul_f32 v40, v40, v48
    v_mfma_f32_32x32x16_bf16 v[192:207], v[92:95], v[116:119], v[192:207]
    ds_read_b128 v[100:103], v13 offset:0
    v_mul_f32 v41, v41, v48
    v_mul_f32 v42, v42, v48
    s_waitcnt lgkmcnt(6)
    v_mfma_f32_32x32x16_bf16 v[176:191], v[72:75], v[136:139], v[176:191]
    v_mov_b32_dpp v64, v72 quad_perm:[0,1,2,3] row_mask:0x5 bank_mask:0xf
    v_mov_b32_dpp v65, v73 quad_perm:[0,1,2,3] row_mask:0x5 bank_mask:0xf
    v_mov_b32_dpp v66, v74 quad_perm:[0,1,2,3] row_mask:0x5 bank_mask:0xf
    v_mov_b32_dpp v67, v75 quad_perm:[0,1,2,3] row_mask:0x5 bank_mask:0xf
    ds_read2_b64 v[88:91], v10 offset0:68 offset1:69
    v_mfma_f32_32x32x16_bf16 v[144:159], v[72:75], v[128:131], v[144:159]
    v_mov_b32_dpp v68, v76 quad_perm:[0,1,2,3] row_mask:0x5 bank_mask:0xf
    v_mov_b32_dpp v69, v77 quad_perm:[0,1,2,3] row_mask:0x5 bank_mask:0xf
    v_mov_b32_dpp v70, v78 quad_perm:[0,1,2,3] row_mask:0x5 bank_mask:0xf
    v_mov_b32_dpp v71, v79 quad_perm:[0,1,2,3] row_mask:0x5 bank_mask:0xf
    ds_read_b128 v[120:123], v15 offset:592
    v_mfma_f32_32x32x16_bf16 v[192:207], v[64:67], v[140:143], v[192:207]
    v_add_u32 v13, 560, v11
    v_min_u32 v13, v13, v12
    ds_read_b128 v[112:115], v13 offset:32
    v_mul_f32 v43, v43, v48
    v_cvt_pk_bf16_f32 v40, 0, v40
    v_mfma_f32_32x32x16_bf16 v[176:191], v[76:79], v[128:131], v[176:191]
    ds_read_b128 v[124:127], v15 offset:560
    v_cvt_pk_bf16_f32 v41, 0, v41
    v_cvt_pk_bf16_f32 v42, 0, v42
    v_mfma_f32_32x32x16_bf16 v[160:175], v[64:67], v[132:135], v[160:175]
    ds_read2_b64 v[92:95], v14 offset0:68 offset1:69
    v_cvt_pk_bf16_f32 v43, 0, v43
    v_and_b32 v44, s40, v23
    v_mfma_f32_32x32x16_bf16 v[192:207], v[68:71], v[132:135], v[192:207]
    ds_read_b128 v[116:119], v13 offset:0
    v_lshlrev_b32 v45, 16, v23
    v_and_b32 v46, s40, v22
    s_waitcnt lgkmcnt(6)
    v_mfma_f32_32x32x16_bf16 v[176:191], v[80:83], v[104:107], v[176:191]
    v_mov_b32_dpp v72, v80 quad_perm:[0,1,2,3] row_mask:0x5 bank_mask:0xf
    v_mov_b32_dpp v73, v81 quad_perm:[0,1,2,3] row_mask:0x5 bank_mask:0xf
    v_mov_b32_dpp v74, v82 quad_perm:[0,1,2,3] row_mask:0x5 bank_mask:0xf
    v_mov_b32_dpp v75, v83 quad_perm:[0,1,2,3] row_mask:0x5 bank_mask:0xf
    ds_read2_b64 v[64:67], v10 offset0:76 offset1:77
    v_mfma_f32_32x32x16_bf16 v[144:159], v[80:83], v[96:99], v[144:159]
    v_mov_b32_dpp v76, v84 quad_perm:[0,1,2,3] row_mask:0x5 bank_mask:0xf
    v_mov_b32_dpp v77, v85 quad_perm:[0,1,2,3] row_mask:0x5 bank_mask:0xf
    v_mov_b32_dpp v78, v86 quad_perm:[0,1,2,3] row_mask:0x5 bank_mask:0xf
    v_mov_b32_dpp v79, v87 quad_perm:[0,1,2,3] row_mask:0x5 bank_mask:0xf
    ds_read_b128 v[136:139], v15 offset:672
    v_mfma_f32_32x32x16_bf16 v[192:207], v[72:75], v[108:111], v[192:207]
    v_add_u32 v13, 640, v11
    v_min_u32 v13, v13, v12
    ds_read_b128 v[128:131], v13 offset:32
    v_lshlrev_b32 v47, 16, v22
    v_mul_f32 v44, v44, v48
    v_mfma_f32_32x32x16_bf16 v[176:191], v[84:87], v[96:99], v[176:191]
    ds_read_b128 v[140:143], v15 offset:640
    v_mul_f32 v45, v45, v48
    v_mul_f32 v46, v46, v48
    v_mfma_f32_32x32x16_bf16 v[160:175], v[72:75], v[100:103], v[160:175]
    ds_read2_b64 v[68:71], v14 offset0:76 offset1:77
    v_mul_f32 v47, v47, v48
    v_cvt_pk_bf16_f32 v44, 0, v44
    v_mfma_f32_32x32x16_bf16 v[192:207], v[76:79], v[100:103], v[192:207]
    ds_read_b128 v[132:135], v13 offset:0
    v_cvt_pk_bf16_f32 v45, 0, v45
    v_cvt_pk_bf16_f32 v46, 0, v46
    s_waitcnt lgkmcnt(6)
    v_mfma_f32_32x32x16_bf16 v[176:191], v[88:91], v[120:123], v[176:191]
    v_mov_b32_dpp v80, v88 quad_perm:[0,1,2,3] row_mask:0x5 bank_mask:0xf
    v_mov_b32_dpp v81, v89 quad_perm:[0,1,2,3] row_mask:0x5 bank_mask:0xf
    v_mov_b32_dpp v82, v90 quad_perm:[0,1,2,3] row_mask:0x5 bank_mask:0xf
    v_mov_b32_dpp v83, v91 quad_perm:[0,1,2,3] row_mask:0x5 bank_mask:0xf
    ds_read2_b64 v[72:75], v10 offset0:84 offset1:85
    v_mfma_f32_32x32x16_bf16 v[144:159], v[88:91], v[112:115], v[144:159]
    v_mov_b32_dpp v84, v92 quad_perm:[0,1,2,3] row_mask:0x5 bank_mask:0xf
    v_mov_b32_dpp v85, v93 quad_perm:[0,1,2,3] row_mask:0x5 bank_mask:0xf
    v_mov_b32_dpp v86, v94 quad_perm:[0,1,2,3] row_mask:0x5 bank_mask:0xf
    v_mov_b32_dpp v87, v95 quad_perm:[0,1,2,3] row_mask:0x5 bank_mask:0xf
    ds_read_b128 v[104:107], v15 offset:752
    v_mfma_f32_32x32x16_bf16 v[192:207], v[80:83], v[124:127], v[192:207]
    v_add_u32 v13, 720, v11
    v_min_u32 v13, v13, v12
    ds_read_b128 v[96:99], v13 offset:32
    v_cvt_pk_bf16_f32 v47, 0, v47
    v_lshlrev_b32 v7, 4, v1
    v_mfma_f32_32x32x16_bf16 v[176:191], v[92:95], v[112:115], v[176:191]
    ds_read_b128 v[108:111], v15 offset:720
    s_lshl_b32 s36, s32, 12
    s_add_u32 s37, s36, s35
    v_mfma_f32_32x32x16_bf16 v[160:175], v[80:83], v[116:119], v[160:175]
    ds_read2_b64 v[76:79], v14 offset0:84 offset1:85
    v_add_u32 v50, s37, v7
    s_xor_b32 s36, s36, 4096
    v_mfma_f32_32x32x16_bf16 v[192:207], v[84:87], v[116:119], v[192:207]
    ds_read_b128 v[100:103], v13 offset:0
    s_add_u32 s37, s36, s35
    v_add_u32 v51, s37, v7
    s_waitcnt lgkmcnt(6)
    v_mfma_f32_32x32x16_bf16 v[176:191], v[64:67], v[136:139], v[176:191]
    v_mov_b32_dpp v88, v64 quad_perm:[0,1,2,3] row_mask:0x5 bank_mask:0xf
    v_mov_b32_dpp v89, v65 quad_perm:[0,1,2,3] row_mask:0x5 bank_mask:0xf
    v_mov_b32_dpp v90, v66 quad_perm:[0,1,2,3] row_mask:0x5 bank_mask:0xf
    v_mov_b32_dpp v91, v67 quad_perm:[0,1,2,3] row_mask:0x5 bank_mask:0xf
    ds_read2_b64 v[80:83], v10 offset0:92 offset1:93
    v_mfma_f32_32x32x16_bf16 v[144:159], v[64:67], v[128:131], v[144:159]
    v_mov_b32_dpp v92, v68 quad_perm:[0,1,2,3] row_mask:0x5 bank_mask:0xf
    v_mov_b32_dpp v93, v69 quad_perm:[0,1,2,3] row_mask:0x5 bank_mask:0xf
    v_mov_b32_dpp v94, v70 quad_perm:[0,1,2,3] row_mask:0x5 bank_mask:0xf
    v_mov_b32_dpp v95, v71 quad_perm:[0,1,2,3] row_mask:0x5 bank_mask:0xf
    ds_read_b128 v[120:123], v15 offset:832
    v_mfma_f32_32x32x16_bf16 v[192:207], v[88:91], v[140:143], v[192:207]
    v_add_u32 v13, 800, v11
    v_min_u32 v13, v13, v12
    ds_read_b128 v[112:115], v13 offset:32
    s_lshl_b32 s37, s32, 11
    s_add_u32 s36, s37, s35
    v_mfma_f32_32x32x16_bf16 v[176:191], v[68:71], v[128:131], v[176:191]
    ds_read_b128 v[124:127], v15 offset:800
    s_add_u32 s36, s36, 35328
    v_lshlrev_b32 v6, 6, v3
    v_mfma_f32_32x32x16_bf16 v[160:175], v[88:91], v[132:135], v[160:175]
    ds_read2_b64 v[84:87], v14 offset0:92 offset1:93
    v_lshl_add_u32 v6, v4, 3, v6
    v_add_u32 v6, s36, v6
    v_mfma_f32_32x32x16_bf16 v[192:207], v[92:95], v[132:135], v[192:207]
    ds_read_b128 v[116:119], v13 offset:0
    v_add_u32 v8, s36, v7
    s_waitcnt lgkmcnt(6)
    v_mfma_f32_32x32x16_bf16 v[176:191], v[72:75], v[104:107], v[176:191]
    v_mov_b32_dpp v64, v72 quad_perm:[0,1,2,3] row_mask:0x5 bank_mask:0xf
    v_mov_b32_dpp v65, v73 quad_perm:[0,1,2,3] row_mask:0x5 bank_mask:0xf
    v_mov_b32_dpp v66, v74 quad_perm:[0,1,2,3] row_mask:0x5 bank_mask:0xf
    v_mov_b32_dpp v67, v75 quad_perm:[0,1,2,3] row_mask:0x5 bank_mask:0xf
    ds_read2_b64 v[88:91], v10 offset0:100 offset1:101
    v_mfma_f32_32x32x16_bf16 v[144:159], v[72:75], v[96:99], v[144:159]
    v_mov_b32_dpp v68, v76 quad_perm:[0,1,2,3] row_mask:0x5 bank_mask:0xf
    v_mov_b32_dpp v69, v77 quad_perm:[0,1,2,3] row_mask:0x5 bank_mask:0xf
    v_mov_b32_dpp v70, v78 quad_perm:[0,1,2,3] row_mask:0x5 bank_mask:0xf
    v_mov_b32_dpp v71, v79 quad_perm:[0,1,2,3] row_mask:0x5 bank_mask:0xf
    ds_read_b128 v[136:139], v15 offset:912
    v_mfma_f32_32x32x16_bf16 v[192:207], v[64:67], v[108:111], v[192:207]
    v_add_u32 v13, 880, v11
    v_min_u32 v13, v13, v12
    ds_read_b128 v[128:131], v13 offset:32
    v_mfma_f32_32x32x16_bf16 v[176:191], v[76:79], v[96:99], v[176:191]
    ds_read_b128 v[140:143], v15 offset:880
    v_mfma_f32_32x32x16_bf16 v[160:175], v[64:67], v[100:103], v[160:175]
    ds_read2_b64 v[92:95], v14 offset0:100 offset1:101
    v_mfma_f32_32x32x16_bf16 v[192:207], v[68:71], v[100:103], v[192:207]
    ds_read_b128 v[132:135], v13 offset:0
    s_waitcnt lgkmcnt(6)
    v_mfma_f32_32x32x16_bf16 v[176:191], v[80:83], v[120:123], v[176:191]
    v_mov_b32_dpp v72, v80 quad_perm:[0,1,2,3] row_mask:0x5 bank_mask:0xf
    v_mov_b32_dpp v73, v81 quad_perm:[0,1,2,3] row_mask:0x5 bank_mask:0xf
    v_mov_b32_dpp v74, v82 quad_perm:[0,1,2,3] row_mask:0x5 bank_mask:0xf
    v_mov_b32_dpp v75, v83 quad_perm:[0,1,2,3] row_mask:0x5 bank_mask:0xf
    ds_read2_b64 v[64:67], v10 offset0:108 offset1:109
    v_mfma_f32_32x32x16_bf16 v[144:159], v[80:83], v[112:115], v[144:159]
    v_mov_b32_dpp v76, v84 quad_perm:[0,1,2,3] row_mask:0x5 bank_mask:0xf
    v_mov_b32_dpp v77, v85 quad_perm:[0,1,2,3] row_mask:0x5 bank_mask:0xf
    v_mov_b32_dpp v78, v86 quad_perm:[0,1,2,3] row_mask:0x5 bank_mask:0xf
    v_mov_b32_dpp v79, v87 quad_perm:[0,1,2,3] row_mask:0x5 bank_mask:0xf
    ds_read_b128 v[104:107], v15 offset:992
    v_mfma_f32_32x32x16_bf16 v[192:207], v[72:75], v[124:127], v[192:207]
    v_add_u32 v13, 960, v11
    v_min_u32 v13, v13, v12
    ds_read_b128 v[96:99], v13 offset:32
    v_mfma_f32_32x32x16_bf16 v[176:191], v[84:87], v[112:115], v[176:191]
    ds_read_b128 v[108:111], v15 offset:960
    v_mfma_f32_32x32x16_bf16 v[160:175], v[72:75], v[116:119], v[160:175]
    ds_read2_b64 v[68:71], v14 offset0:108 offset1:109
    v_mfma_f32_32x32x16_bf16 v[192:207], v[76:79], v[116:119], v[192:207]
    ds_read_b128 v[100:103], v13 offset:0
    s_waitcnt lgkmcnt(6)
    v_mfma_f32_32x32x16_bf16 v[176:191], v[88:91], v[136:139], v[176:191]
    v_mov_b32_dpp v80, v88 quad_perm:[0,1,2,3] row_mask:0x5 bank_mask:0xf
    v_mov_b32_dpp v81, v89 quad_perm:[0,1,2,3] row_mask:0x5 bank_mask:0xf
    v_mov_b32_dpp v82, v90 quad_perm:[0,1,2,3] row_mask:0x5 bank_mask:0xf
    v_mov_b32_dpp v83, v91 quad_perm:[0,1,2,3] row_mask:0x5 bank_mask:0xf
    ds_read2_b64 v[72:75], v10 offset0:116 offset1:117
    v_mfma_f32_32x32x16_bf16 v[144:159], v[88:91], v[128:131], v[144:159]
    v_mov_b32_dpp v84, v92 quad_perm:[0,1,2,3] row_mask:0x5 bank_mask:0xf
    v_mov_b32_dpp v85, v93 quad_perm:[0,1,2,3] row_mask:0x5 bank_mask:0xf
    v_mov_b32_dpp v86, v94 quad_perm:[0,1,2,3] row_mask:0x5 bank_mask:0xf
    v_mov_b32_dpp v87, v95 quad_perm:[0,1,2,3] row_mask:0x5 bank_mask:0xf
    ds_read_b128 v[120:123], v15 offset:1072
    v_mfma_f32_32x32x16_bf16 v[192:207], v[80:83], v[140:143], v[192:207]
    v_add_u32 v13, 1040, v11
    v_min_u32 v13, v13, v12
    ds_read_b128 v[112:115], v13 offset:32
    v_mfma_f32_32x32x16_bf16 v[176:191], v[92:95], v[128:131], v[176:191]
    ds_read_b128 v[124:127], v15 offset:1040
    v_mfma_f32_32x32x16_bf16 v[160:175], v[80:83], v[132:135], v[160:175]
    ds_read2_b64 v[76:79], v14 offset0:116 offset1:117
    v_mfma_f32_32x32x16_bf16 v[192:207], v[84:87], v[132:135], v[192:207]
    ds_read_b128 v[116:119], v13 offset:0
    s_waitcnt lgkmcnt(6)
    v_mfma_f32_32x32x16_bf16 v[176:191], v[64:67], v[104:107], v[176:191]
    v_mov_b32_dpp v88, v64 quad_perm:[0,1,2,3] row_mask:0x5 bank_mask:0xf
    v_mov_b32_dpp v89, v65 quad_perm:[0,1,2,3] row_mask:0x5 bank_mask:0xf
    v_mov_b32_dpp v90, v66 quad_perm:[0,1,2,3] row_mask:0x5 bank_mask:0xf
    v_mov_b32_dpp v91, v67 quad_perm:[0,1,2,3] row_mask:0x5 bank_mask:0xf
    ds_read2_b64 v[80:83], v10 offset0:124 offset1:125
    v_mfma_f32_32x32x16_bf16 v[144:159], v[64:67], v[96:99], v[144:159]
    v_mov_b32_dpp v92, v68 quad_perm:[0,1,2,3] row_mask:0x5 bank_mask:0xf
    v_mov_b32_dpp v93, v69 quad_perm:[0,1,2,3] row_mask:0x5 bank_mask:0xf
    v_mov_b32_dpp v94, v70 quad_perm:[0,1,2,3] row_mask:0x5 bank_mask:0xf
    v_mov_b32_dpp v95, v71 quad_perm:[0,1,2,3] row_mask:0x5 bank_mask:0xf
    ds_read_b128 v[136:139], v15 offset:1152
    v_mfma_f32_32x32x16_bf16 v[192:207], v[88:91], v[108:111], v[192:207]
    v_add_u32 v13, 1120, v11
    v_min_u32 v13, v13, v12
    ds_read_b128 v[128:131], v13 offset:32
    v_mfma_f32_32x32x16_bf16 v[176:191], v[68:71], v[96:99], v[176:191]
    ds_read_b128 v[140:143], v15 offset:1120
    v_mfma_f32_32x32x16_bf16 v[160:175], v[88:91], v[100:103], v[160:175]
    ds_read2_b64 v[84:87], v14 offset0:124 offset1:125
    v_mfma_f32_32x32x16_bf16 v[192:207], v[92:95], v[100:103], v[192:207]
    ds_read_b128 v[132:135], v13 offset:0
    s_waitcnt lgkmcnt(6)
    v_mfma_f32_32x32x16_bf16 v[176:191], v[72:75], v[120:123], v[176:191]
    v_mov_b32_dpp v64, v72 quad_perm:[0,1,2,3] row_mask:0x5 bank_mask:0xf
    v_mov_b32_dpp v65, v73 quad_perm:[0,1,2,3] row_mask:0x5 bank_mask:0xf
    v_mov_b32_dpp v66, v74 quad_perm:[0,1,2,3] row_mask:0x5 bank_mask:0xf
    v_mov_b32_dpp v67, v75 quad_perm:[0,1,2,3] row_mask:0x5 bank_mask:0xf
    ds_read2_b64 v[88:91], v10 offset0:132 offset1:133
    v_mfma_f32_32x32x16_bf16 v[144:159], v[72:75], v[112:115], v[144:159]
    v_mov_b32_dpp v68, v76 quad_perm:[0,1,2,3] row_mask:0x5 bank_mask:0xf
    v_mov_b32_dpp v69, v77 quad_perm:[0,1,2,3] row_mask:0x5 bank_mask:0xf
    v_mov_b32_dpp v70, v78 quad_perm:[0,1,2,3] row_mask:0x5 bank_mask:0xf
    v_mov_b32_dpp v71, v79 quad_perm:[0,1,2,3] row_mask:0x5 bank_mask:0xf
    ds_read_b128 v[104:107], v15 offset:1232
    v_mfma_f32_32x32x16_bf16 v[192:207], v[64:67], v[124:127], v[192:207]
    v_add_u32 v13, 1200, v11
    v_min_u32 v13, v13, v12
    ds_read_b128 v[96:99], v13 offset:32
    v_mfma_f32_32x32x16_bf16 v[176:191], v[76:79], v[112:115], v[176:191]
    ds_read_b128 v[108:111], v15 offset:1200
    v_mfma_f32_32x32x16_bf16 v[160:175], v[64:67], v[116:119], v[160:175]
    ds_read2_b64 v[92:95], v14 offset0:132 offset1:133
    v_mfma_f32_32x32x16_bf16 v[192:207], v[68:71], v[116:119], v[192:207]
    ds_read_b128 v[100:103], v13 offset:0
    s_waitcnt lgkmcnt(6)
    v_mfma_f32_32x32x16_bf16 v[176:191], v[80:83], v[136:139], v[176:191]
    v_mov_b32_dpp v72, v80 quad_perm:[0,1,2,3] row_mask:0x5 bank_mask:0xf
    v_mov_b32_dpp v73, v81 quad_perm:[0,1,2,3] row_mask:0x5 bank_mask:0xf
    v_mov_b32_dpp v74, v82 quad_perm:[0,1,2,3] row_mask:0x5 bank_mask:0xf
    v_mov_b32_dpp v75, v83 quad_perm:[0,1,2,3] row_mask:0x5 bank_mask:0xf
    v_mfma_f32_32x32x16_bf16 v[144:159], v[80:83], v[128:131], v[144:159]
    v_mov_b32_dpp v76, v84 quad_perm:[0,1,2,3] row_mask:0x5 bank_mask:0xf
    v_mov_b32_dpp v77, v85 quad_perm:[0,1,2,3] row_mask:0x5 bank_mask:0xf
    v_mov_b32_dpp v78, v86 quad_perm:[0,1,2,3] row_mask:0x5 bank_mask:0xf
    v_mov_b32_dpp v79, v87 quad_perm:[0,1,2,3] row_mask:0x5 bank_mask:0xf
    v_mfma_f32_32x32x16_bf16 v[192:207], v[72:75], v[140:143], v[192:207]
    v_mfma_f32_32x32x16_bf16 v[176:191], v[84:87], v[128:131], v[176:191]
    v_mfma_f32_32x32x16_bf16 v[160:175], v[72:75], v[132:135], v[160:175]
    v_mfma_f32_32x32x16_bf16 v[192:207], v[76:79], v[132:135], v[192:207]
    s_waitcnt lgkmcnt(0)
    v_mfma_f32_32x32x16_bf16 v[176:191], v[88:91], v[104:107], v[176:191]
    v_mov_b32_dpp v80, v88 quad_perm:[0,1,2,3] row_mask:0x5 bank_mask:0xf
    v_mov_b32_dpp v81, v89 quad_perm:[0,1,2,3] row_mask:0x5 bank_mask:0xf
    v_mov_b32_dpp v82, v90 quad_perm:[0,1,2,3] row_mask:0x5 bank_mask:0xf
    v_mov_b32_dpp v83, v91 quad_perm:[0,1,2,3] row_mask:0x5 bank_mask:0xf
    v_mfma_f32_32x32x16_bf16 v[144:159], v[88:91], v[96:99], v[144:159]
    v_mov_b32_dpp v84, v92 quad_perm:[0,1,2,3] row_mask:0x5 bank_mask:0xf
    v_mov_b32_dpp v85, v93 quad_perm:[0,1,2,3] row_mask:0x5 bank_mask:0xf
    v_mov_b32_dpp v86, v94 quad_perm:[0,1,2,3] row_mask:0x5 bank_mask:0xf
    v_mov_b32_dpp v87, v95 quad_perm:[0,1,2,3] row_mask:0x5 bank_mask:0xf
    v_mfma_f32_32x32x16_bf16 v[192:207], v[80:83], v[108:111], v[192:207]
    v_mfma_f32_32x32x16_bf16 v[176:191], v[92:95], v[96:99], v[176:191]
    v_mfma_f32_32x32x16_bf16 v[160:175], v[80:83], v[100:103], v[160:175]
    v_mfma_f32_32x32x16_bf16 v[192:207], v[84:87], v[100:103], v[192:207]
    s_cmp_eq_u32 s32, 0
    s_cbranch_scc1 conv_hw0
    s_nop 7
    v_add_f32 v80, v144, v168
    v_add_f32 v81, v145, v169
    v_add_f32 v82, v146, v170
    v_add_f32 v83, v147, v171
    v_add_f32 v84, v148, v172
    v_add_f32 v85, v149, v173
    v_add_f32 v86, v150, v174
    v_add_f32 v87, v151, v175
    v_add_f32 v88, v152, v160
    v_add_f32 v89, v153, v161
    v_add_f32 v90, v154, v162
    v_add_f32 v91, v155, v163
    v_add_f32 v92, v156, v164
    v_add_f32 v93, v157, v165
    v_add_f32 v94, v158, v166
    v_add_f32 v95, v159, v167
    ds_write_b128 v50, v[80:83] offset:27136
    ds_write_b128 v50, v[84:87] offset:28160
    ds_write_b128 v50, v[88:91] offset:29184
    ds_write_b128 v50, v[92:95] offset:30208
    v_add_f32 v64, v176, v200
    v_add_f32 v65, v177, v201
    v_add_f32 v66, v178, v202
    v_add_f32 v67, v179, v203
    v_add_f32 v68, v180, v204
    v_add_f32 v69, v181, v205
    v_add_f32 v70, v182, v206
    v_add_f32 v71, v183, v207
    v_add_f32 v72, v184, v192
    v_add_f32 v73, v185, v193
    v_add_f32 v74, v186, v194
    v_add_f32 v75, v187, v195
    v_add_f32 v76, v188, v196
    v_add_f32 v77, v189, v197
    v_add_f32 v78, v190, v198
    v_add_f32 v79, v191, v199
    s_branch conv_x
conv_hw0:
    s_nop 15
    s_nop 3
    v_add_f32 v80, v176, v200
    v_add_f32 v81, v177, v201
    v_add_f32 v82, v178, v202
    v_add_f32 v83, v179, v203
    v_add_f32 v84, v180, v204
    v_add_f32 v85, v181, v205
    v_add_f32 v86, v182, v206
    v_add_f32 v87, v183, v207
    v_add_f32 v88, v184, v192
    v_add_f32 v89, v185, v193
    v_add_f32 v90, v186, v194
    v_add_f32 v91, v187, v195
    v_add_f32 v92, v188, v196
    v_add_f32 v93, v189, v197
    v_add_f32 v94, v190, v198
    v_add_f32 v95, v191, v199
    ds_write_b128 v50, v[80:83] offset:27136
    ds_write_b128 v50, v[84:87] offset:28160
    ds_write_b128 v50, v[88:91] offset:29184
    ds_write_b128 v50, v[92:95] offset:30208
    v_add_f32 v64, v144, v168
    v_add_f32 v65, v145, v169
    v_add_f32 v66, v146, v170
    v_add_f32 v67, v147, v171
    v_add_f32 v68, v148, v172
    v_add_f32 v69, v149, v173
    v_add_f32 v70, v150, v174
    v_add_f32 v71, v151, v175
    v_add_f32 v72, v152, v160
    v_add_f32 v73, v153, v161
    v_add_f32 v74, v154, v162
    v_add_f32 v75, v155, v163
    v_add_f32 v76, v156, v164
    v_add_f32 v77, v157, v165
    v_add_f32 v78, v158, v166
    v_add_f32 v79, v159, v167
conv_x:
    s_waitcnt lgkmcnt(0)
    s_barrier
    ds_read_b128 v[80:83], v51 offset:27136
    ds_read_b128 v[84:87], v51 offset:28160
    ds_read_b128 v[88:91], v51 offset:29184
    ds_read_b128 v[92:95], v51 offset:30208
    s_waitcnt lgkmcnt(3)
    v_add_f32 v64, v64, v80
    v_add_f32 v65, v65, v81
    v_add_f32 v66, v66, v82
    v_add_f32 v67, v67, v83
    v_cvt_pk_bf16_f32 v64, 0, v64
    v_cvt_pk_bf16_f32 v65, 0, v65
    v_cvt_pk_bf16_f32 v66, 0, v66
    v_cvt_pk_bf16_f32 v67, 0, v67
    v_add_f32 v64, v64, v32
    v_add_f32 v65, v65, v33
    v_add_f32 v66, v66, v34
    v_add_f32 v67, v67, v35
    v_cvt_pk_bf16_f32 v110, v64, v65
    v_cvt_pk_bf16_f32 v111, v66, v67
    ds_write_b64 v6, v[110:111] offset:0
    s_waitcnt lgkmcnt(3)
    v_add_f32 v68, v68, v84
    v_add_f32 v69, v69, v85
    v_add_f32 v70, v70, v86
    v_add_f32 v71, v71, v87
    v_cvt_pk_bf16_f32 v68, 0, v68
    v_cvt_pk_bf16_f32 v69, 0, v69
    v_cvt_pk_bf16_f32 v70, 0, v70
    v_cvt_pk_bf16_f32 v71, 0, v71
    v_add_f32 v68, v68, v36
    v_add_f32 v69, v69, v37
    v_add_f32 v70, v70, v38
    v_add_f32 v71, v71, v39
    v_cvt_pk_bf16_f32 v112, v68, v69
    v_cvt_pk_bf16_f32 v113, v70, v71
    ds_write_b64 v6, v[112:113] offset:16
    s_waitcnt lgkmcnt(3)
    v_add_f32 v72, v72, v88
    v_add_f32 v73, v73, v89
    v_add_f32 v74, v74, v90
    v_add_f32 v75, v75, v91
    v_cvt_pk_bf16_f32 v72, 0, v72
    v_cvt_pk_bf16_f32 v73, 0, v73
    v_cvt_pk_bf16_f32 v74, 0, v74
    v_cvt_pk_bf16_f32 v75, 0, v75
    v_add_f32 v72, v72, v40
    v_add_f32 v73, v73, v41
    v_add_f32 v74, v74, v42
    v_add_f32 v75, v75, v43
    v_cvt_pk_bf16_f32 v114, v72, v73
    v_cvt_pk_bf16_f32 v115, v74, v75
    ds_write_b64 v6, v[114:115] offset:32
    s_waitcnt lgkmcnt(3)
    v_add_f32 v76, v76, v92
    v_add_f32 v77, v77, v93
    v_add_f32 v78, v78, v94
    v_add_f32 v79, v79, v95
    v_cvt_pk_bf16_f32 v76, 0, v76
    v_cvt_pk_bf16_f32 v77, 0, v77
    v_cvt_pk_bf16_f32 v78, 0, v78
    v_cvt_pk_bf16_f32 v79, 0, v79
    v_add_f32 v76, v76, v44
    v_add_f32 v77, v77, v45
    v_add_f32 v78, v78, v46
    v_add_f32 v79, v79, v47
    v_cvt_pk_bf16_f32 v116, v76, v77
    v_cvt_pk_bf16_f32 v117, v78, v79
    ds_write_b64 v6, v[116:117] offset:48
    s_waitcnt lgkmcnt(0)
    ds_read_b128 v[104:107], v8
    ds_read_b128 v[108:111], v8 offset:1024
    s_waitcnt lgkmcnt(1)
    buffer_store_dwordx4 v[104:107], v7, s[24:27], s37 offen sc0 sc1
    s_waitcnt lgkmcnt(0)
    buffer_store_dwordx4 v[108:111], v7, s[24:27], s37 offen offset:1024 sc0 sc1
    s_lshl_b32 s36, s32, 12
    s_lshl_b32 s37, s30, 3
    s_add_u32 s47, s36, s37
    s_add_u32 s47, s47, 24576
    s_waitcnt vmcnt(0)
    s_lshl_b32 s93, s47, 4
    s_mov_b64 exec, 1
    buffer_store_dwordx2 v[252:253], off, s[56:59], s93 sc0 sc1
    s_mov_b64 exec, -1
    s_endpgm
k_done:
    s_endpgm
.section .rodata,"a"
.p2align 6
.amdhsa_kernel parallel_sum__ssm_conv_h3__glu_gated_bilinear__prompt_kernel
  .amdhsa_next_free_vgpr 256
  .amdhsa_next_free_sgpr 102
  .amdhsa_accum_offset 256
  .amdhsa_group_segment_fixed_size 0
  .amdhsa_kernarg_size 104
  .amdhsa_user_sgpr_count 2
  .amdhsa_user_sgpr_kernarg_segment_ptr 1
  .amdhsa_system_sgpr_workgroup_id_x 1
.end_amdhsa_kernel
```
